```python
import torch

def _softmax(x, axis=-1):
    return torch.softmax(x, dim=axis)
def _gelu(x):
    return torch.nn.functional.gelu(x, approximate="tanh")
def _silu(x):
    return torch.nn.functional.silu(x)
def _sigmoid(x):
    return torch.sigmoid(x)
def _layernorm(x, axis=-1, eps=1e-5):
    m = x.mean(dim=axis, keepdim=True)
    v = x.var(dim=axis, keepdim=True, unbiased=False)
    return (x - m) / torch.sqrt(v + eps)
def _scatter_add(tgt, idx, src, axis=0):
    return tgt.clone().index_add_(axis, idx, src)
def _segment_sum(src, seg, n):
    out = torch.zeros((n,) + src.shape[1:], dtype=src.dtype)
    return out.index_add_(0, seg, src)
def _pad(x, pw):
    flat = tuple(v for pair in reversed(pw) for v in pair)
    return torch.nn.functional.pad(x, flat)

kernel_name = 'parallel_sum__linear_kernel_hedgehog__dense_activation_squared_relu__prompt'

def setup_inputs():

    _w = (lambda a: (lambda t: t.to(torch.bfloat16) if t.is_floating_point() else t)(torch.as_tensor(a)))
    def _A_setup():
        B, S, D, H = 1, 2048, 512, 32
        Dh = D // H
        return {
            "x": _w((lambda *s: torch.randn(*s, dtype=torch.bfloat16) * 0.05)(B, S, D)),
            "wqkv": _w((lambda *s: torch.randn(*s, dtype=torch.bfloat16) * 0.8)(D, 3 * D)),
            "w_phi": _w((lambda *s: torch.randn(*s, dtype=torch.bfloat16) * 0.8)(H, Dh, Dh) * (Dh ** -0.5)),
            "wo": _w((lambda *s: torch.randn(*s, dtype=torch.bfloat16) * 0.2)(D, D)),
        }
    _A_in = _A_setup()

    def _B_setup():
        B, S, D, F = 1, 2048, 512, 1376
        return {
            "x": _w((lambda *s: torch.randn(*s, dtype=torch.bfloat16) * 0.05)(B, S, D)),
            "w1": _w((lambda *s: torch.randn(*s, dtype=torch.bfloat16) * 0.05)(D, F)),
            "b1": _w((lambda *s: torch.randn(*s, dtype=torch.bfloat16) * 0.8)(F)),
            "w2": _w((lambda *s: torch.randn(*s, dtype=torch.bfloat16) * 0.05)(F, D)),
            "b2": _w((lambda *s: torch.randn(*s, dtype=torch.bfloat16) * 3.2)(D)),
        }
    _B_in = _B_setup()

    return {
        "A_x": _A_in["x"],
        "A_wqkv": _A_in["wqkv"],
        "A_w_phi": _A_in["w_phi"],
        "A_wo": _A_in["wo"],
        "B_x": _B_in["x"],
        "B_w1": _B_in["w1"],
        "B_b1": _B_in["b1"],
        "B_w2": _B_in["w2"],
        "B_b2": _B_in["b2"],
    }

def reference(A_x, A_wqkv, A_w_phi, A_wo, B_x, B_w1, B_b1, B_w2, B_b2):
    def _A_ref(x, wqkv, w_phi, wo):
        B, S, D = x.shape
        H = 32; Dh = D // H
        qkv = (lambda x, *d: x.permute(*d))((x @ wqkv).reshape(B, S, 3, H, Dh), 2, 0, 3, 1, 4)
        q, k, v = qkv[0], qkv[1], qkv[2]
        pq = torch.einsum("bhsd,hdf->bhsf", q, w_phi)
        pk = torch.einsum("bhsd,hdf->bhsf", k, w_phi)
        phi_q = torch.concatenate([_softmax(pq, axis=-1), _softmax(-pq, axis=-1)], axis=-1)
        phi_k = torch.concatenate([_softmax(pk, axis=-1), _softmax(-pk, axis=-1)], axis=-1)
        kv = torch.einsum("bhsf,bhsd->bhfd", phi_k, v)
        z  = torch.einsum("bhsf->bhf", phi_k)
        num = torch.einsum("bhqf,bhfd->bhqd", phi_q, kv)
        den = torch.einsum("bhqf,bhf->bhq", phi_q, z)[..., None] + 1e-6
        o = num / den
        return (lambda x, *d: x.permute(*d))(o, 0, 2, 1, 3).reshape(B, S, D) @ wo

    def _B_ref(x, w1, b1, w2, b2):
        h = torch.einsum("bsd,df->bsf", x, w1) + b1
        zero = torch.zeros_like(h)
        r = torch.where(h > zero, h, zero)
        h = r * r
        out = torch.einsum("bsf,fd->bsd", h, w2) + b2
        return out

    x = A_x
    xn = _layernorm(x, axis=-1)
    return x + _A_ref(xn, A_wqkv, A_w_phi, A_wo) + _B_ref(xn, B_w1, B_b1, B_w2, B_b2)
```

```asm
; @launch grid=(256,1,1) block=(512,1,1) lds=163840
.amdgcn_target "amdgcn-amd-amdhsa--gfx950"
.text
.globl parallel_sum__linear_kernel_hedgehog__dense_activation_squared_relu__prompt_kernel
.p2align 8
.type parallel_sum__linear_kernel_hedgehog__dense_activation_squared_relu__prompt_kernel,@function
parallel_sum__linear_kernel_hedgehog__dense_activation_squared_relu__prompt_kernel:
    s_cmp_ge_u32 s2, 256
    s_cbranch_scc1 .Lend
    s_cmp_ge_u32 s2, 128
    s_cbranch_scc1 .Lqpath
    s_load_dwordx2 s[4:5], s[0:1], 0
    s_load_dwordx2 s[8:9], s[0:1], 8
    s_load_dwordx2 s[28:29], s[0:1], 40
    s_load_dwordx2 s[12:13], s[0:1], 88
    s_load_dwordx2 s[16:17], s[0:1], 80
    s_load_dwordx2 s[20:21], s[0:1], 56
    s_load_dwordx2 s[24:25], s[0:1], 24
    s_load_dwordx2 s[80:81], s[0:1], 16
    s_load_dwordx2 s[84:85], s[0:1], 48
    v_lshrrev_b32 v3, 6, v0
    v_and_b32 v1, 63, v0
    v_readfirstlane_b32 s98, v3
    s_bfe_u32 s33, s2, 0x30003
    s_bfe_u32 s34, s2, 0x10002
    s_lshl_b32 s34, s34, 3
    s_add_u32 s33, s33, s34
    s_lshr_b32 s34, s2, 6
    s_lshl_b32 s35, s34, 1
    s_add_u32 s35, s35, s33
    s_and_b32 s35, s35, 7
    s_and_b32 s34, s34, 1
    s_lshl_b32 s34, s34, 2
    s_and_b32 s99, s2, 3
    s_add_u32 s99, s99, s34
    v_lshrrev_b32 v112, 3, v1
    v_lshrrev_b32 v113, 4, v1
    v_and_b32 v114, 7, v1
    s_lshl_b32 s96, s98, 10
    s_lshl_b32 s97, s98, 11
    s_lshl_b32 s34, s98, 14
    v_xor_b32 v16, v114, v113
    v_lshl_add_u32 v17, v112, 10, s34
    v_lshl_add_u32 v16, v16, 4, v17
    v_and_b32 v113, 1, v113
    v_xor_b32 v17, 64, v16
    v_lshlrev_b32 v113, 2, v113
    v_add_u32 v17, 7168, v17
    v_xor_b32 v113, v114, v113
    s_lshl_b32 s34, s98, 3
    v_add_u32 v112, s34, v112
    s_lshl_b32 s34, s99, 7
    s_lshl_b32 s32, s33, 17
    v_lshl_add_u32 v113, v113, 4, s34
    v_mul_u32_u24 v114, 3072, v112
    s_lshl_b32 s33, s35, 7
    s_add_u32 s32, s32, s33
    s_mul_i32 s40, s35, 196608
    v_add3_u32 v18, v114, v113, 0
    v_lshlrev_b32 v30, 4, v1
    s_and_b32 s33, s2, 7
    s_lshl_b32 s33, s33, 18
    s_lshr_b32 s95, s2, 3
    s_lshl_b32 s95, s95, 13
    s_or_b32 s33, s33, s95
    s_add_u32 s33, s33, s96
    s_mov_b32 s6, 2097152
    s_mov_b32 s7, 0x20000
    s_mov_b32 s10, 1572864
    s_mov_b32 s11, 0x20000
    s_mov_b32 s30, 1409024
    s_mov_b32 s31, 0x20000
    v_add_u32 v18, 1024, v18
    s_getpc_b64 s[100:101]
    s_add_u32 s100, s100, tblw@rel32@lo+4
    s_addc_u32 s101, s101, tblw@rel32@hi+12
    s_lshl_b32 s37, s99, 11
    s_and_b32 s38, s96, 0x1000
    s_lshr_b32 s38, s38, 2
    s_add_u32 s37, s37, s38
    s_mov_b32 s82, 16384
    s_mov_b32 s83, 0x20000
    s_add_u32 m0, s38, 131072
    s_and_b32 s38, s96, 0xc00
    s_waitcnt lgkmcnt(0)
    s_cbranch_scc1 .Lwp1
    buffer_load_dwordx4 v30, s[80:83], s37 offen lds
.Lwp1:
    buffer_load_dwordx4 v[224:227], v30, s[4:7], s33 offen
    s_add_u32 m0, s97, 0
    s_nop 0
    buffer_load_dwordx4 v16, s[4:7], s32 offen lds
    buffer_load_dwordx4 v17, s[4:7], s32 offen offset:1024 lds
    s_add_u32 m0, s97, 16384
    s_nop 0
    buffer_load_dwordx4 v18, s[8:11], s40 offen lds
    buffer_load_dwordx4 v18, s[8:11], s40 offen offset:1024 lds
    s_cmp_lg_u32 s96, 7168
    s_cbranch_scc1 .Lcp2
    s_getpc_b64 s[90:91]
    s_add_u32 s90, s90, parallel_sum__linear_kernel_hedgehog__dense_activation_squared_relu__prompt_kernel@rel32@lo+4
    s_addc_u32 s91, s91, parallel_sum__linear_kernel_hedgehog__dense_activation_squared_relu__prompt_kernel@rel32@hi+12
    s_lshr_b32 s92, s2, 3
    s_mul_i32 s92, s92, 1536
    v_min_u32 v119, 11, v1
    v_lshl_add_u32 v119, v119, 7, s92
    v_min_u32 v119, (.Lend - parallel_sum__linear_kernel_hedgehog__dense_activation_squared_relu__prompt_kernel), v119
    global_load_dword v245, v119, s[90:91]
.Lcp2:
    s_lshl_b32 s3, s2, 7
    s_lshr_b32 s34, s96, 4
    s_add_u32 s34, s34, 32768
    s_load_dwordx16 s[64:79], s[100:101], s34
    s_add_u32 s34, s3, 64
    s_load_dwordx16 s[48:63], s[100:101], s34
    s_bfe_u32 s34, s2, 0x30003
    s_lshl_b32 s34, s34, 2
    s_lshr_b32 s35, s2, 6
    s_add_u32 s34, s34, s35
    s_lshl_b32 s34, s34, 9
    s_lshr_b32 s35, s96, 11
    s_lshl_b32 s35, s35, 7
    s_add_u32 s34, s34, s35
    s_add_u32 s34, s34, 33280
    s_load_dword s88, s[100:101], s34
    s_add_u32 s34, s34, 64
    s_load_dword s89, s[100:101], s34
    s_nop 0
    s_load_dwordx16 s[32:47], s[100:101], s3
    s_mov_b32 s14, 268435456
    s_mov_b32 s15, 0x20000
    s_mov_b32 s18, 256
    s_mov_b32 s19, 0x20000
    s_mov_b32 s22, 1409024
    s_mov_b32 s23, 0x20000
    s_mov_b32 s26, 1966080
    s_mov_b32 s27, 0x20000
    s_mov_b32 s86, 2752
    s_mov_b32 s87, 0x20000
    s_sub_u32 s24, s24, 1441792
    s_subb_u32 s25, s25, 0
    s_lshr_b32 s98, s98, 2
    s_cmp_lg_u32 s2, 0
    s_cbranch_scc1 .Lnonon
    s_memrealtime s[92:93]
    v_cmp_eq_u32 vcc, 0, v0
    v_mov_b32 v118, 0x1000
    s_nop 0
    v_cndmask_b32_e64 v118, v118, 0, vcc
    s_waitcnt lgkmcnt(0)
    s_or_b32 s92, s92, 1
    v_mov_b32 v116, s92
    v_mov_b32 v117, s93
    buffer_store_dwordx2 v[116:117], v118, s[16:19], 0 offen sc1
    s_nop 1
.Lnonon:
    v_and_b32 v2, 31, v1
    v_lshrrev_b32 v3, 5, v1
    v_mul_u32_u24 v19, 2752, v112
    v_and_b32 v113, 0x70, v113
    v_bfe_u32 v84, v1, 1, 3
    v_add_u32 v19, v19, v113
    v_xor_b32 v84, v84, v3
    v_bfe_u32 v114, v1, 2, 2
    v_lshlrev_b32 v87, 7, v114
    v_lshrrev_b32 v114, 1, v114
    v_xor_b32 v114, s98, v114
    v_lshl_add_u32 v87, v114, 6, v87
    v_bfe_u32 v114, v1, 4, 1
    v_lshl_add_u32 v87, v114, 5, v87
    v_and_b32 v114, 3, v1
    v_lshl_add_u32 v87, v114, 3, v87
    v_lshl_add_u32 v86, v3, 10, v87
    v_lshl_add_u32 v87, v3, 11, v87
    v_add_u32 v86, 98304, v86
    v_add_u32 v87, 16384, v87
    v_bfe_u32 v120, v1, 2, 2
    v_lshl_add_u32 v120, v3, 2, v120
    v_and_b32 v121, 3, v1
    v_lshlrev_b32 v120, 5, v120
    v_lshl_add_u32 v120, v121, 3, v120
    v_bfe_u32 v123, v1, 4, 1
    s_lshl_b32 s3, s98, 10
    s_add_u32 s3, s3, 131072
    v_lshl_add_u32 v120, v123, 9, v120
    v_add_u32 v120, s3, v120
    v_add_u32 v123, -1, v123
    v_lshlrev_b32 v121, 1, v2
    v_mul_u32_u24 v114, 2752, v1
    v_mov_b32 v83, 0x3f803f80
    v_cmp_eq_u32 vcc, 0, v2
    s_nop 1
    v_cndmask_b32_e64 v64, 0, v83, vcc
    v_cmp_eq_u32 vcc, 20, v2
    s_nop 1
    v_cndmask_b32_e64 v64, v64, v83, vcc
    v_cmp_eq_u32 vcc, 8, v2
    s_nop 1
    v_cndmask_b32_e64 v68, 0, v83, vcc
    v_cmp_eq_u32 vcc, 28, v2
    s_nop 1
    v_cndmask_b32_e64 v68, v68, v83, vcc
    v_mov_b32 v65, v64
    v_mov_b32 v69, v68
    v_mov_b32 v66, v64
    v_mov_b32 v70, v68
    v_mov_b32 v67, v64
    v_mov_b32 v71, v68
    s_waitcnt lgkmcnt(0)
    s_barrier
    s_add_u32 m0, s97, 32768
    s_nop 0
    buffer_load_dwordx4 v16, s[4:7], s33 offen lds
    buffer_load_dwordx4 v17, s[4:7], s33 offen offset:1024 lds
    s_add_u32 m0, s97, 49152
    s_nop 0
    buffer_load_dwordx4 v18, s[8:11], s41 offen lds
    buffer_load_dwordx4 v18, s[8:11], s41 offen offset:1024 lds
    s_add_u32 s50, s50, s70
    v_add_u32 v19, s48, v19
    s_add_u32 s63, s63, s71
    s_add_u32 s63, s63, 33280
    buffer_load_ushort v246, v121, s[84:87], s50 offen
    v_and_b32 v25, 1, v1
    v_lshlrev_b32 v25, 2, v25
    buffer_load_dword v25, v25, s[16:19], 0 offen sc1
    v_lshl_add_u32 v85, v2, 7, s68
    s_add_u32 s51, s51, s64
    s_add_u32 s52, s52, s65
    s_add_u32 s53, s53, s66
    s_add_u32 s58, s58, s67
    v_xor_b32 v4, s72, v84
    v_lshl_add_u32 v8, s76, 1, v87
    v_lshl_add_u32 v4, v4, 4, v85
    v_add_u32 v12, s76, v86
    v_xor_b32 v5, s73, v84
    v_lshl_add_u32 v9, s77, 1, v87
    v_lshl_add_u32 v5, v5, 4, v85
    v_add_u32 v13, s77, v86
    v_xor_b32 v6, s74, v84
    v_lshl_add_u32 v10, s78, 1, v87
    v_lshl_add_u32 v6, v6, 4, v85
    v_add_u32 v14, s78, v86
    v_xor_b32 v7, s75, v84
    v_lshl_add_u32 v11, s79, 1, v87
    v_lshl_add_u32 v7, v7, 4, v85
    v_add_u32 v15, s79, v86
    s_add_u32 s3, s63, 64
    s_load_dwordx16 s[64:79], s[100:101], s63
    s_load_dwordx16 s[80:95], s[100:101], s3
    s_waitcnt vmcnt(6)
    s_waitcnt lgkmcnt(0)
    s_barrier
    ds_read_b128 v[128:131], v4
    ds_read_b64_tr_b16 v[80:81], v8 offset:0
    ds_read_b64_tr_b16 v[82:83], v8 offset:512
    ds_read_b64_tr_b16 v[84:85], v8 offset:1024
    ds_read_b64_tr_b16 v[86:87], v8 offset:1536
    ds_read_b128 v[132:135], v5
    ds_read_b64_tr_b16 v[88:89], v9 offset:0
    ds_read_b64_tr_b16 v[90:91], v9 offset:512
    ds_read_b64_tr_b16 v[92:93], v9 offset:1024
    ds_read_b64_tr_b16 v[94:95], v9 offset:1536
    ds_read_b64_tr_b16 v[112:113], v120
    ds_read_b64_tr_b16 v[114:115], v120 offset:256
    s_add_u32 m0, s97, 65536
    s_waitcnt lgkmcnt(9)
    v_mfma_f32_32x32x16_bf16 v[32:47], v[80:83], v[128:131], 0
    buffer_load_dwordx4 v16, s[4:7], s34 offen lds
    ds_read_b128 v[136:139], v6
    ds_read_b64_tr_b16 v[96:97], v10 offset:0
    ds_read_b64_tr_b16 v[98:99], v10 offset:512
    ds_read_b64_tr_b16 v[100:101], v10 offset:1024
    ds_read_b64_tr_b16 v[102:103], v10 offset:1536
    v_mfma_f32_16x16x32_bf16 v[72:75], v[64:67], v[80:83], 0
    v_lshlrev_b32 v228, 16, v224
    v_and_b32 v229, 0xffff0000, v224
    v_lshlrev_b32 v230, 16, v225
    v_and_b32 v231, 0xffff0000, v225
    v_lshlrev_b32 v232, 16, v226
    v_and_b32 v233, 0xffff0000, v226
    v_lshlrev_b32 v234, 16, v227
    s_add_u32 m0, s97, 65536
    s_waitcnt lgkmcnt(12)
    v_mfma_f32_32x32x16_bf16 v[48:63], v[128:131], v[84:87], 0
    buffer_load_dwordx4 v17, s[4:7], s34 offen offset:1024 lds
    ds_read_b128 v[140:143], v7
    ds_read_b64_tr_b16 v[104:105], v11 offset:0
    ds_read_b64_tr_b16 v[106:107], v11 offset:512
    ds_read_b64_tr_b16 v[108:109], v11 offset:1024
    ds_read_b64_tr_b16 v[110:111], v11 offset:1536
    v_mfma_f32_16x16x32_bf16 v[72:75], v[68:71], v[84:87], v[72:75]
    v_and_b32 v235, 0xffff0000, v227
    v_add_f32 v236, v228, v229
    v_add_f32 v237, v230, v231
    v_add_f32 v236, v236, v232
    v_add_f32 v237, v237, v233
    v_add_f32 v236, v236, v234
    v_add_f32 v237, v237, v235
    v_add_f32 v236, v236, v237
    s_add_u32 m0, s97, 81920
    s_waitcnt lgkmcnt(14)
    v_mfma_f32_32x32x16_bf16 v[32:47], v[88:91], v[132:135], v[32:47]
    buffer_load_dwordx4 v18, s[8:11], s42 offen lds
    v_add_f32_dpp v236, v236, v236 row_ror:8 row_mask:0xf bank_mask:0xf
    s_nop 1
    v_add_f32_dpp v236, v236, v236 row_ror:4 row_mask:0xf bank_mask:0xf
    s_nop 1
    v_add_f32_dpp v236, v236, v236 row_ror:2 row_mask:0xf bank_mask:0xf
    s_nop 1
    v_add_f32_dpp v236, v236, v236 row_ror:1 row_mask:0xf bank_mask:0xf
    v_mov_b32 v237, v236
    s_nop 1
    v_permlane16_swap_b32 v236, v237
    v_add_f32 v236, v236, v237
    s_add_u32 m0, s97, 81920
    s_waitcnt lgkmcnt(12)
    v_mfma_f32_32x32x16_bf16 v[48:63], v[132:135], v[92:95], v[48:63]
    buffer_load_dwordx4 v18, s[8:11], s42 offen offset:1024 lds
    v_mov_b32 v237, v236
    s_nop 1
    v_permlane32_swap_b32 v236, v237
    v_add_f32 v236, v236, v237
    v_mul_f32 v238, 0x3b000000, v236
    v_sub_f32 v228, v228, v238
    v_sub_f32 v229, v229, v238
    v_sub_f32 v230, v230, v238
    v_sub_f32 v231, v231, v238
    s_add_u32 m0, s97, 98304
    s_waitcnt lgkmcnt(7)
    v_mfma_f32_32x32x16_bf16 v[32:47], v[96:99], v[136:139], v[32:47]
    buffer_load_dwordx4 v16, s[4:7], s35 offen lds
    s_waitcnt vmcnt(7)
    s_barrier
    v_add_u32 v4, 0x8000, v4
    v_add_u32 v8, 0x8000, v8
    ds_read_b128 v[144:147], v4
    ds_read_b64_tr_b16 v[80:81], v8 offset:0
    ds_read_b64_tr_b16 v[82:83], v8 offset:512
    ds_read_b64_tr_b16 v[84:85], v8 offset:1024
    ds_read_b64_tr_b16 v[86:87], v8 offset:1536
    v_sub_f32 v232, v232, v238
    v_sub_f32 v233, v233, v238
    v_sub_f32 v234, v234, v238
    v_sub_f32 v235, v235, v238
    v_mul_f32 v236, v228, v228
    v_mul_f32 v237, v229, v229
    v_fmac_f32 v236, v230, v230
    v_fmac_f32 v237, v231, v231
    s_add_u32 m0, s97, 98304
    s_waitcnt lgkmcnt(10)
    v_mfma_f32_32x32x16_bf16 v[48:63], v[136:139], v[100:103], v[48:63]
    buffer_load_dwordx4 v17, s[4:7], s35 offen offset:1024 lds
    v_add_u32 v5, 0x8000, v5
    v_add_u32 v9, 0x8000, v9
    ds_read_b128 v[148:151], v5
    ds_read_b64_tr_b16 v[88:89], v9 offset:0
    ds_read_b64_tr_b16 v[90:91], v9 offset:512
    ds_read_b64_tr_b16 v[92:93], v9 offset:1024
    ds_read_b64_tr_b16 v[94:95], v9 offset:1536
    v_fmac_f32 v236, v232, v232
    v_fmac_f32 v237, v233, v233
    v_fmac_f32 v236, v234, v234
    v_fmac_f32 v237, v235, v235
    v_add_f32 v236, v236, v237
    s_nop 1
    v_add_f32_dpp v236, v236, v236 row_ror:8 row_mask:0xf bank_mask:0xf
    s_nop 1
    v_add_f32_dpp v236, v236, v236 row_ror:4 row_mask:0xf bank_mask:0xf
    s_add_u32 m0, s97, 114688
    s_waitcnt lgkmcnt(12)
    v_mfma_f32_32x32x16_bf16 v[32:47], v[104:107], v[140:143], v[32:47]
    buffer_load_dwordx4 v18, s[8:11], s43 offen lds
    v_add_f32_dpp v236, v236, v236 row_ror:2 row_mask:0xf bank_mask:0xf
    s_nop 1
    v_add_f32_dpp v236, v236, v236 row_ror:1 row_mask:0xf bank_mask:0xf
    v_mov_b32 v237, v236
    s_nop 1
    v_permlane16_swap_b32 v236, v237
    v_add_f32 v236, v236, v237
    v_mov_b32 v237, v236
    s_nop 1
    v_permlane32_swap_b32 v236, v237
    v_add_f32 v236, v236, v237
    s_add_u32 m0, s97, 114688
    s_waitcnt lgkmcnt(10)
    v_mfma_f32_32x32x16_bf16 v[48:63], v[140:143], v[108:111], v[48:63]
    buffer_load_dwordx4 v18, s[8:11], s43 offen offset:1024 lds
    v_mul_f32 v236, 0x3b000000, v236
    v_cvt_pk_bf16_f32 v237, v236, v236
    v_and_b32 v236, 0xffff0000, v237
    v_add_f32 v236, 0x3727c5ac, v236
    v_cvt_pk_bf16_f32 v237, v236, v236
    v_and_b32 v236, 0xffff0000, v237
    v_sqrt_f32 v236, v236
    s_nop 0
    v_cvt_pk_bf16_f32 v21, v238, v236
    s_waitcnt lgkmcnt(7)
    v_mfma_f32_32x32x16_bf16 v[32:47], v[80:83], v[144:147], v[32:47]
    v_add_u32 v6, 0x8000, v6
    v_add_u32 v10, 0x8000, v10
    ds_read_b128 v[152:155], v6
    ds_read_b64_tr_b16 v[96:97], v10 offset:0
    ds_read_b64_tr_b16 v[98:99], v10 offset:512
    ds_read_b64_tr_b16 v[100:101], v10 offset:1024
    ds_read_b64_tr_b16 v[102:103], v10 offset:1536
    v_mfma_f32_16x16x32_bf16 v[72:75], v[64:67], v[80:83], v[72:75]
    s_add_u32 m0, s97, 131072
    s_waitcnt lgkmcnt(10)
    v_mfma_f32_32x32x16_bf16 v[48:63], v[144:147], v[84:87], v[48:63]
    buffer_load_dwordx4 v16, s[4:7], s36 offen lds
    v_add_u32 v7, 0x8000, v7
    v_add_u32 v11, 0x8000, v11
    ds_read_b128 v[156:159], v7
    ds_read_b64_tr_b16 v[104:105], v11 offset:0
    ds_read_b64_tr_b16 v[106:107], v11 offset:512
    ds_read_b64_tr_b16 v[108:109], v11 offset:1024
    ds_read_b64_tr_b16 v[110:111], v11 offset:1536
    v_mfma_f32_16x16x32_bf16 v[72:75], v[68:71], v[84:87], v[72:75]
    s_waitcnt vmcnt(9)
    s_mov_b32 s3, 0
.Lnz3:
    v_readlane_b32 s100, v25, 0
    v_readlane_b32 s101, v25, 1
    s_add_u32 s3, s3, 1
    s_cmp_lg_u32 s100, 0
    s_cbranch_scc1 .Lnzok4
    s_cmp_ge_u32 s3, 20000
    s_cbranch_scc1 .Lnzok4
    s_sleep 8
    v_and_b32 v25, 1, v1
    v_lshlrev_b32 v25, 2, v25
    buffer_load_dword v25, v25, s[16:19], 0 offen sc1
    s_waitcnt vmcnt(0)
    s_branch .Lnz3
.Lnzok4:
    v_cmp_eq_u32 vcc, 0, v1
    v_mov_b32 v25, 0x20000000
    s_and_b32 s48, s2, 7
    s_lshl_b32 s48, s48, 18
    s_lshr_b32 s95, s2, 3
    s_lshl_b32 s95, s95, 13
    s_or_b32 s48, s48, s95
    s_lshr_b32 s48, s48, 7
    s_lshr_b32 s49, s96, 7
    s_add_u32 s48, s48, s49
    v_cndmask_b32_e64 v25, v25, 0, vcc
    v_mov_b32 v22, v21
    v_mov_b32 v23, s100
    s_add_u32 s48, s48, 16384
    buffer_store_dwordx2 v[22:23], v25, s[12:15], s48 offen sc1
    s_waitcnt lgkmcnt(12)
    v_mfma_f32_32x32x16_bf16 v[32:47], v[88:91], v[148:151], v[32:47]
    s_add_u32 m0, s97, 131072
    s_waitcnt lgkmcnt(10)
    v_mfma_f32_32x32x16_bf16 v[48:63], v[148:151], v[92:95], v[48:63]
    buffer_load_dwordx4 v17, s[4:7], s36 offen offset:1024 lds
    v_and_b32 v116, v123, v112
    v_and_b32 v117, v123, v113
    v_and_b32 v118, v123, v114
    v_and_b32 v119, v123, v115
    v_xor_b32 v116, v116, v112
    v_xor_b32 v117, v117, v113
    v_xor_b32 v118, v118, v114
    v_xor_b32 v119, v119, v115
    v_xor_b32 v112, v116, v112
    v_xor_b32 v113, v117, v113
    v_xor_b32 v114, v118, v114
    v_xor_b32 v115, v119, v115
    s_waitcnt lgkmcnt(7)
    v_mfma_f32_32x32x16_bf16 v[32:47], v[96:99], v[152:155], v[32:47]
    s_waitcnt vmcnt(7)
    s_barrier
    v_add_u32 v4, 0x8000, v4
    v_add_u32 v8, 0x8000, v8
    ds_read_b128 v[160:163], v4
    ds_read_b64_tr_b16 v[80:81], v8 offset:0
    ds_read_b64_tr_b16 v[82:83], v8 offset:512
    ds_read_b64_tr_b16 v[84:85], v8 offset:1024
    ds_read_b64_tr_b16 v[86:87], v8 offset:1536
    s_add_u32 m0, s97, 147456
    s_waitcnt lgkmcnt(10)
    v_mfma_f32_32x32x16_bf16 v[48:63], v[152:155], v[100:103], v[48:63]
    buffer_load_dwordx4 v18, s[8:11], s44 offen lds
    v_add_u32 v5, 0x8000, v5
    v_add_u32 v9, 0x8000, v9
    ds_read_b128 v[164:167], v5
    ds_read_b64_tr_b16 v[88:89], v9 offset:0
    ds_read_b64_tr_b16 v[90:91], v9 offset:512
    ds_read_b64_tr_b16 v[92:93], v9 offset:1024
    ds_read_b64_tr_b16 v[94:95], v9 offset:1536
    v_cmp_gt_u32 vcc, 34, v0
    v_mov_b32 v26, 0x20000000
    v_mov_b32 v120, 0
    v_mov_b32 v121, 0
    v_mov_b32 v122, 0
    v_mov_b32 v123, 0
    v_cndmask_b32_e64 v26, v26, v30, vcc
    buffer_store_dwordx4 v[120:123], v26, s[12:15], s60 offen sc1
    s_waitcnt lgkmcnt(12)
    v_mfma_f32_32x32x16_bf16 v[32:47], v[104:107], v[156:159], v[32:47]
    s_add_u32 m0, s97, 147456
    s_waitcnt lgkmcnt(10)
    v_mfma_f32_32x32x16_bf16 v[48:63], v[156:159], v[108:111], v[48:63]
    buffer_load_dwordx4 v18, s[8:11], s44 offen offset:1024 lds
    s_waitcnt lgkmcnt(7)
    v_mfma_f32_32x32x16_bf16 v[32:47], v[80:83], v[160:163], v[32:47]
    v_add_u32 v6, 0x8000, v6
    v_add_u32 v10, 0x8000, v10
    ds_read_b128 v[168:171], v6
    ds_read_b64_tr_b16 v[96:97], v10 offset:0
    ds_read_b64_tr_b16 v[98:99], v10 offset:512
    ds_read_b64_tr_b16 v[100:101], v10 offset:1024
    ds_read_b64_tr_b16 v[102:103], v10 offset:1536
    v_mfma_f32_16x16x32_bf16 v[72:75], v[64:67], v[80:83], v[72:75]
    s_add_u32 m0, s97, 0
    s_waitcnt lgkmcnt(10)
    v_mfma_f32_32x32x16_bf16 v[48:63], v[160:163], v[84:87], v[48:63]
    buffer_load_dwordx4 v16, s[4:7], s37 offen lds
    v_add_u32 v7, 0x8000, v7
    v_add_u32 v11, 0x8000, v11
    ds_read_b128 v[172:175], v7
    ds_read_b64_tr_b16 v[104:105], v11 offset:0
    ds_read_b64_tr_b16 v[106:107], v11 offset:512
    ds_read_b64_tr_b16 v[108:109], v11 offset:1024
    ds_read_b64_tr_b16 v[110:111], v11 offset:1536
    v_mfma_f32_16x16x32_bf16 v[72:75], v[68:71], v[84:87], v[72:75]
    s_waitcnt lgkmcnt(12)
    v_mfma_f32_32x32x16_bf16 v[32:47], v[88:91], v[164:167], v[32:47]
    v_mov_b32 v27, 0x3f80
    v_mov_b32 v28, 0x3f800000
    v_lshlrev_b32 v26, 2, v3
    v_sub_u32 v26, v2, v26
    v_subrev_u32 v26, 16, v26
    v_cmp_eq_u32 vcc, 0, v26
    v_cmp_eq_u32_e64 s[48:49], 1, v26
    s_nop 0
    v_cndmask_b32_e64 v124, 0, v27, vcc
    v_cndmask_b32_e64 v124, v124, v28, s[48:49]
    v_cmp_eq_u32 vcc, 2, v26
    v_cmp_eq_u32_e64 s[48:49], 3, v26
    s_nop 0
    v_cndmask_b32_e64 v125, 0, v27, vcc
    v_cndmask_b32_e64 v125, v125, v28, s[48:49]
    v_cmp_eq_u32 vcc, 8, v26
    v_cmp_eq_u32_e64 s[48:49], 9, v26
    s_nop 0
    v_cndmask_b32_e64 v126, 0, v27, vcc
    v_cndmask_b32_e64 v126, v126, v28, s[48:49]
    v_cmp_eq_u32 vcc, 10, v26
    v_cmp_eq_u32_e64 s[48:49], 11, v26
    s_nop 0
    v_cndmask_b32_e64 v127, 0, v27, vcc
    v_cndmask_b32_e64 v127, v127, v28, s[48:49]
    s_add_u32 m0, s97, 0
    s_waitcnt lgkmcnt(10)
    v_mfma_f32_32x32x16_bf16 v[48:63], v[164:167], v[92:95], v[48:63]
    buffer_load_dwordx4 v17, s[4:7], s37 offen offset:1024 lds
    s_waitcnt lgkmcnt(7)
    v_mfma_f32_32x32x16_bf16 v[32:47], v[96:99], v[168:171], v[32:47]
    s_waitcnt vmcnt(8)
    s_barrier
    v_add_u32 v4, 0x8000, v4
    v_add_u32 v8, 0x8000, v8
    ds_read_b128 v[176:179], v4
    ds_read_b64_tr_b16 v[80:81], v8 offset:0
    ds_read_b64_tr_b16 v[82:83], v8 offset:512
    ds_read_b64_tr_b16 v[84:85], v8 offset:1024
    ds_read_b64_tr_b16 v[86:87], v8 offset:1536
    s_add_u32 m0, s97, 16384
    s_waitcnt lgkmcnt(10)
    v_mfma_f32_32x32x16_bf16 v[48:63], v[168:171], v[100:103], v[48:63]
    buffer_load_dwordx4 v18, s[8:11], s45 offen lds
    v_add_u32 v5, 0x8000, v5
    v_add_u32 v9, 0x8000, v9
    ds_read_b128 v[180:183], v5
    ds_read_b64_tr_b16 v[88:89], v9 offset:0
    ds_read_b64_tr_b16 v[90:91], v9 offset:512
    ds_read_b64_tr_b16 v[92:93], v9 offset:1024
    ds_read_b64_tr_b16 v[94:95], v9 offset:1536
    s_waitcnt lgkmcnt(12)
    v_mfma_f32_32x32x16_bf16 v[32:47], v[104:107], v[172:175], v[32:47]
    v_mov_b32 v27, 0x3f80
    v_mov_b32 v28, 0x3f800000
    v_lshlrev_b32 v26, 2, v3
    v_sub_u32 v26, v2, v26
    v_cmp_eq_u32 vcc, 0, v26
    v_cmp_eq_u32_e64 s[48:49], 1, v26
    s_nop 0
    v_cndmask_b32_e64 v120, 0, v27, vcc
    v_cndmask_b32_e64 v120, v120, v28, s[48:49]
    v_cmp_eq_u32 vcc, 2, v26
    v_cmp_eq_u32_e64 s[48:49], 3, v26
    s_nop 0
    v_cndmask_b32_e64 v121, 0, v27, vcc
    v_cndmask_b32_e64 v121, v121, v28, s[48:49]
    v_cmp_eq_u32 vcc, 8, v26
    v_cmp_eq_u32_e64 s[48:49], 9, v26
    s_nop 0
    v_cndmask_b32_e64 v122, 0, v27, vcc
    v_cndmask_b32_e64 v122, v122, v28, s[48:49]
    v_cmp_eq_u32 vcc, 10, v26
    v_cmp_eq_u32_e64 s[48:49], 11, v26
    s_nop 0
    v_cndmask_b32_e64 v123, 0, v27, vcc
    v_cndmask_b32_e64 v123, v123, v28, s[48:49]
    s_add_u32 m0, s97, 16384
    s_waitcnt lgkmcnt(10)
    v_mfma_f32_32x32x16_bf16 v[48:63], v[172:175], v[108:111], v[48:63]
    buffer_load_dwordx4 v18, s[8:11], s45 offen offset:1024 lds
    s_waitcnt lgkmcnt(7)
    v_mfma_f32_32x32x16_bf16 v[32:47], v[80:83], v[176:179], v[32:47]
    v_add_u32 v6, 0x8000, v6
    v_add_u32 v10, 0x8000, v10
    ds_read_b128 v[184:187], v6
    ds_read_b64_tr_b16 v[96:97], v10 offset:0
    ds_read_b64_tr_b16 v[98:99], v10 offset:512
    ds_read_b64_tr_b16 v[100:101], v10 offset:1024
    ds_read_b64_tr_b16 v[102:103], v10 offset:1536
    v_mfma_f32_16x16x32_bf16 v[72:75], v[64:67], v[80:83], v[72:75]
    s_add_u32 m0, s97, 32768
    s_waitcnt lgkmcnt(10)
    v_mfma_f32_32x32x16_bf16 v[48:63], v[176:179], v[84:87], v[48:63]
    buffer_load_dwordx4 v16, s[4:7], s38 offen lds
    v_add_u32 v7, 0x8000, v7
    v_add_u32 v11, 0x8000, v11
    ds_read_b128 v[188:191], v7
    ds_read_b64_tr_b16 v[104:105], v11 offset:0
    ds_read_b64_tr_b16 v[106:107], v11 offset:512
    ds_read_b64_tr_b16 v[108:109], v11 offset:1024
    ds_read_b64_tr_b16 v[110:111], v11 offset:1536
    v_mfma_f32_16x16x32_bf16 v[72:75], v[68:71], v[84:87], v[72:75]
    s_waitcnt lgkmcnt(12)
    v_mfma_f32_32x32x16_bf16 v[32:47], v[88:91], v[180:183], v[32:47]
    v_lshlrev_b32 v0, 16, v246
    s_add_u32 m0, s97, 32768
    s_waitcnt lgkmcnt(10)
    v_mfma_f32_32x32x16_bf16 v[48:63], v[180:183], v[92:95], v[48:63]
    buffer_load_dwordx4 v17, s[4:7], s38 offen offset:1024 lds
    s_waitcnt lgkmcnt(7)
    v_mfma_f32_32x32x16_bf16 v[32:47], v[96:99], v[184:187], v[32:47]
    s_waitcnt vmcnt(6)
    s_barrier
    v_add_u32 v4, 0x8000, v4
    v_add_u32 v8, 0x8000, v8
    ds_read_b128 v[192:195], v4
    ds_read_b64_tr_b16 v[80:81], v8 offset:0
    ds_read_b64_tr_b16 v[82:83], v8 offset:512
    ds_read_b64_tr_b16 v[84:85], v8 offset:1024
    ds_read_b64_tr_b16 v[86:87], v8 offset:1536
    s_add_u32 m0, s97, 49152
    s_waitcnt lgkmcnt(10)
    v_mfma_f32_32x32x16_bf16 v[48:63], v[184:187], v[100:103], v[48:63]
    buffer_load_dwordx4 v18, s[8:11], s46 offen lds
    v_add_u32 v5, 0x8000, v5
    v_add_u32 v9, 0x8000, v9
    ds_read_b128 v[196:199], v5
    ds_read_b64_tr_b16 v[88:89], v9 offset:0
    ds_read_b64_tr_b16 v[90:91], v9 offset:512
    ds_read_b64_tr_b16 v[92:93], v9 offset:1024
    ds_read_b64_tr_b16 v[94:95], v9 offset:1536
    s_waitcnt lgkmcnt(12)
    v_mfma_f32_32x32x16_bf16 v[32:47], v[104:107], v[188:191], v[32:47]
    s_add_u32 m0, s97, 49152
    s_waitcnt lgkmcnt(10)
    v_mfma_f32_32x32x16_bf16 v[48:63], v[188:191], v[108:111], v[48:63]
    buffer_load_dwordx4 v18, s[8:11], s46 offen offset:1024 lds
    s_waitcnt lgkmcnt(7)
    v_mfma_f32_32x32x16_bf16 v[32:47], v[80:83], v[192:195], v[32:47]
    v_add_u32 v6, 0x8000, v6
    v_add_u32 v10, 0x8000, v10
    ds_read_b128 v[200:203], v6
    ds_read_b64_tr_b16 v[96:97], v10 offset:0
    ds_read_b64_tr_b16 v[98:99], v10 offset:512
    ds_read_b64_tr_b16 v[100:101], v10 offset:1024
    ds_read_b64_tr_b16 v[102:103], v10 offset:1536
    v_mfma_f32_16x16x32_bf16 v[72:75], v[64:67], v[80:83], v[72:75]
    s_add_u32 m0, s97, 65536
    s_waitcnt lgkmcnt(10)
    v_mfma_f32_32x32x16_bf16 v[48:63], v[192:195], v[84:87], v[48:63]
    buffer_load_dwordx4 v16, s[4:7], s39 offen lds
    v_add_u32 v7, 0x8000, v7
    v_add_u32 v11, 0x8000, v11
    ds_read_b128 v[204:207], v7
    ds_read_b64_tr_b16 v[104:105], v11 offset:0
    ds_read_b64_tr_b16 v[106:107], v11 offset:512
    ds_read_b64_tr_b16 v[108:109], v11 offset:1024
    ds_read_b64_tr_b16 v[110:111], v11 offset:1536
    v_mfma_f32_16x16x32_bf16 v[72:75], v[68:71], v[84:87], v[72:75]
    s_waitcnt lgkmcnt(12)
    v_mfma_f32_32x32x16_bf16 v[32:47], v[88:91], v[196:199], v[32:47]
    s_add_u32 m0, s97, 65536
    s_waitcnt lgkmcnt(10)
    v_mfma_f32_32x32x16_bf16 v[48:63], v[196:199], v[92:95], v[48:63]
    buffer_load_dwordx4 v17, s[4:7], s39 offen offset:1024 lds
    s_waitcnt lgkmcnt(7)
    v_mfma_f32_32x32x16_bf16 v[32:47], v[96:99], v[200:203], v[32:47]
    s_waitcnt vmcnt(6)
    s_barrier
    v_add_u32 v4, 0xfffe0000, v4
    v_add_u32 v8, 0xfffe0000, v8
    ds_read_b128 v[208:211], v4
    ds_read_b64_tr_b16 v[80:81], v8 offset:0
    ds_read_b64_tr_b16 v[82:83], v8 offset:512
    ds_read_b64_tr_b16 v[84:85], v8 offset:1024
    ds_read_b64_tr_b16 v[86:87], v8 offset:1536
    s_add_u32 m0, s97, 81920
    s_waitcnt lgkmcnt(10)
    v_mfma_f32_32x32x16_bf16 v[48:63], v[200:203], v[100:103], v[48:63]
    buffer_load_dwordx4 v18, s[8:11], s47 offen lds
    v_add_u32 v5, 0xfffe0000, v5
    v_add_u32 v9, 0xfffe0000, v9
    ds_read_b128 v[212:215], v5
    ds_read_b64_tr_b16 v[88:89], v9 offset:0
    ds_read_b64_tr_b16 v[90:91], v9 offset:512
    ds_read_b64_tr_b16 v[92:93], v9 offset:1024
    ds_read_b64_tr_b16 v[94:95], v9 offset:1536
    s_waitcnt lgkmcnt(12)
    v_mfma_f32_32x32x16_bf16 v[32:47], v[104:107], v[204:207], v[32:47]
    s_add_u32 m0, s97, 81920
    s_waitcnt lgkmcnt(10)
    v_mfma_f32_32x32x16_bf16 v[48:63], v[204:207], v[108:111], v[48:63]
    buffer_load_dwordx4 v18, s[8:11], s47 offen offset:1024 lds
    s_bfe_u32 s32, s32, 0x30007
    s_mul_i32 s32, s32, 176128
    s_bfe_u32 s33, s33, 0x30007
    s_mul_i32 s33, s33, 176128
    s_bfe_u32 s34, s34, 0x30007
    s_mul_i32 s34, s34, 176128
    s_bfe_u32 s35, s35, 0x30007
    s_mul_i32 s35, s35, 176128
    s_waitcnt lgkmcnt(7)
    v_mfma_f32_32x32x16_bf16 v[32:47], v[80:83], v[208:211], v[32:47]
    v_add_u32 v6, 0xfffe0000, v6
    v_add_u32 v10, 0xfffe0000, v10
    ds_read_b128 v[216:219], v6
    ds_read_b64_tr_b16 v[96:97], v10 offset:0
    ds_read_b64_tr_b16 v[98:99], v10 offset:512
    ds_read_b64_tr_b16 v[100:101], v10 offset:1024
    ds_read_b64_tr_b16 v[102:103], v10 offset:1536
    v_mfma_f32_16x16x32_bf16 v[72:75], v[64:67], v[80:83], v[72:75]
    s_add_u32 m0, s96, 98304
    s_waitcnt lgkmcnt(10)
    v_mfma_f32_32x32x16_bf16 v[48:63], v[208:211], v[84:87], v[48:63]
    buffer_load_dwordx4 v19, s[28:31], s32 offen lds
    v_add_u32 v7, 0xfffe0000, v7
    v_add_u32 v11, 0xfffe0000, v11
    ds_read_b128 v[220:223], v7
    ds_read_b64_tr_b16 v[104:105], v11 offset:0
    ds_read_b64_tr_b16 v[106:107], v11 offset:512
    ds_read_b64_tr_b16 v[108:109], v11 offset:1024
    ds_read_b64_tr_b16 v[110:111], v11 offset:1536
    v_mfma_f32_16x16x32_bf16 v[72:75], v[68:71], v[84:87], v[72:75]
    s_waitcnt lgkmcnt(12)
    v_mfma_f32_32x32x16_bf16 v[32:47], v[88:91], v[212:215], v[32:47]
    s_add_u32 m0, s96, 106496
    s_waitcnt lgkmcnt(10)
    v_mfma_f32_32x32x16_bf16 v[48:63], v[212:215], v[92:95], v[48:63]
    buffer_load_dwordx4 v19, s[28:31], s33 offen lds
    s_bfe_u32 s36, s36, 0x30007
    s_mul_i32 s36, s36, 176128
    s_bfe_u32 s37, s37, 0x30007
    s_mul_i32 s37, s37, 176128
    s_bfe_u32 s38, s38, 0x30007
    s_mul_i32 s38, s38, 176128
    s_bfe_u32 s39, s39, 0x30007
    s_mul_i32 s39, s39, 176128
    s_waitcnt lgkmcnt(7)
    v_mfma_f32_32x32x16_bf16 v[32:47], v[96:99], v[216:219], v[32:47]
    s_waitcnt vmcnt(6)
    s_barrier
    v_add_u32 v4, 0x8000, v4
    v_add_u32 v8, 0x8000, v8
    ds_read_b128 v[224:227], v4
    ds_read_b64_tr_b16 v[80:81], v8 offset:0
    ds_read_b64_tr_b16 v[82:83], v8 offset:512
    ds_read_b64_tr_b16 v[84:85], v8 offset:1024
    ds_read_b64_tr_b16 v[86:87], v8 offset:1536
    s_add_u32 m0, s96, 114688
    s_waitcnt lgkmcnt(10)
    v_mfma_f32_32x32x16_bf16 v[48:63], v[216:219], v[100:103], v[48:63]
    buffer_load_dwordx4 v19, s[28:31], s34 offen lds
    v_add_u32 v5, 0x8000, v5
    v_add_u32 v9, 0x8000, v9
    ds_read_b128 v[228:231], v5
    ds_read_b64_tr_b16 v[88:89], v9 offset:0
    ds_read_b64_tr_b16 v[90:91], v9 offset:512
    ds_read_b64_tr_b16 v[92:93], v9 offset:1024
    ds_read_b64_tr_b16 v[94:95], v9 offset:1536
    s_waitcnt lgkmcnt(12)
    v_mfma_f32_32x32x16_bf16 v[32:47], v[104:107], v[220:223], v[32:47]
    s_cmp_eq_u32 s96, 0
    v_mov_b32 v26, s100
    s_cselect_b32 s48, s55, 0x20000000
    s_add_u32 s48, s48, 4096
    buffer_store_dword v26, v25, s[12:15], s48 offen sc1
    s_add_u32 m0, s96, 122880
    s_waitcnt lgkmcnt(10)
    v_mfma_f32_32x32x16_bf16 v[48:63], v[220:223], v[108:111], v[48:63]
    buffer_load_dwordx4 v19, s[28:31], s35 offen lds
    v_lshlrev_b32 v21, 3, v2
    buffer_load_dwordx2 v[22:23], v21, s[12:15], s52 offen sc1
    s_add_u32 m0, s96, 131072
    s_waitcnt lgkmcnt(7)
    v_mfma_f32_32x32x16_bf16 v[32:47], v[80:83], v[224:227], v[32:47]
    buffer_load_dwordx4 v19, s[28:31], s36 offen lds
    v_add_u32 v6, 0x8000, v6
    v_add_u32 v10, 0x8000, v10
    ds_read_b128 v[232:235], v6
    ds_read_b64_tr_b16 v[96:97], v10 offset:0
    ds_read_b64_tr_b16 v[98:99], v10 offset:512
    ds_read_b64_tr_b16 v[100:101], v10 offset:1024
    ds_read_b64_tr_b16 v[102:103], v10 offset:1536
    v_mfma_f32_16x16x32_bf16 v[72:75], v[64:67], v[80:83], v[72:75]
    s_waitcnt lgkmcnt(10)
    v_mfma_f32_32x32x16_bf16 v[48:63], v[224:227], v[84:87], v[48:63]
    v_add_u32 v7, 0x8000, v7
    v_add_u32 v11, 0x8000, v11
    ds_read_b128 v[236:239], v7
    ds_read_b64_tr_b16 v[104:105], v11 offset:0
    ds_read_b64_tr_b16 v[106:107], v11 offset:512
    ds_read_b64_tr_b16 v[108:109], v11 offset:1024
    ds_read_b64_tr_b16 v[110:111], v11 offset:1536
    v_mfma_f32_16x16x32_bf16 v[72:75], v[68:71], v[84:87], v[72:75]
    v_bfe_u32 v17, v1, 4, 1
    v_and_b32 v16, 7, v1
    v_lshlrev_b32 v17, 2, v17
    s_bfe_u32 s48, s96, 0x1000a
    v_xor_b32 v16, v16, v17
    s_lshl_b32 s48, s48, 13
    v_lshrrev_b32 v17, 3, v1
    s_add_u32 s48, s48, s61
    v_lshl_add_u32 v16, v16, 4, s48
    v_lshl_add_u32 v16, v17, 10, v16
    s_add_u32 m0, s96, 139264
    s_waitcnt lgkmcnt(12)
    v_mfma_f32_32x32x16_bf16 v[32:47], v[88:91], v[228:231], v[32:47]
    buffer_load_dwordx4 v19, s[28:31], s37 offen lds
    s_waitcnt lgkmcnt(10)
    v_mfma_f32_32x32x16_bf16 v[48:63], v[228:231], v[92:95], v[48:63]
    s_add_u32 m0, s96, 147456
    s_waitcnt lgkmcnt(7)
    v_mfma_f32_32x32x16_bf16 v[32:47], v[96:99], v[232:235], v[32:47]
    buffer_load_dwordx4 v19, s[28:31], s38 offen lds
    s_waitcnt vmcnt(9)
    s_barrier
    v_add_u32 v4, 0x8000, v4
    v_add_u32 v8, 0x8000, v8
    ds_read_b128 v[240:243], v4
    ds_read_b64_tr_b16 v[80:81], v8 offset:0
    ds_read_b64_tr_b16 v[82:83], v8 offset:512
    ds_read_b64_tr_b16 v[84:85], v8 offset:1024
    ds_read_b64_tr_b16 v[86:87], v8 offset:1536
    s_waitcnt lgkmcnt(10)
    v_mfma_f32_32x32x16_bf16 v[48:63], v[232:235], v[100:103], v[48:63]
    v_add_u32 v5, 0x8000, v5
    v_add_u32 v9, 0x8000, v9
    ds_read_b128 v[244:247], v5
    ds_read_b64_tr_b16 v[88:89], v9 offset:0
    ds_read_b64_tr_b16 v[90:91], v9 offset:512
    ds_read_b64_tr_b16 v[92:93], v9 offset:1024
    ds_read_b64_tr_b16 v[94:95], v9 offset:1536
    s_add_u32 m0, s96, 155648
    s_waitcnt lgkmcnt(12)
    v_mfma_f32_32x32x16_bf16 v[32:47], v[104:107], v[236:239], v[32:47]
    buffer_load_dwordx4 v19, s[28:31], s39 offen lds
    s_waitcnt lgkmcnt(10)
    v_mfma_f32_32x32x16_bf16 v[48:63], v[236:239], v[108:111], v[48:63]
    s_lshr_b32 s48, s96, 2
    s_lshl_b32 s49, s98, 10
    s_add_u32 s48, s48, 24576
    s_add_u32 s49, s49, 24576
    v_lshl_add_u32 v17, v1, 2, s48
    v_lshl_add_u32 v18, v1, 2, s49
    v_add_u32 v20, -1, v3
    s_add_u32 m0, s96, 0
    s_lshl_b32 s63, s64, 4
    buffer_load_dwordx4 v16, s[20:23], s63 offen lds
    s_waitcnt lgkmcnt(7)
    v_mfma_f32_32x32x16_bf16 v[32:47], v[80:83], v[240:243], v[32:47]
    v_add_u32 v6, 0x8000, v6
    v_add_u32 v10, 0x8000, v10
    ds_read_b128 v[248:251], v6
    ds_read_b64_tr_b16 v[96:97], v10 offset:0
    ds_read_b64_tr_b16 v[98:99], v10 offset:512
    ds_read_b64_tr_b16 v[100:101], v10 offset:1024
    ds_read_b64_tr_b16 v[102:103], v10 offset:1536
    v_mfma_f32_16x16x32_bf16 v[76:79], v[64:67], v[80:83], 0
    ds_write_b32 v17, v72 offset:6144
    v_mov_b32 v26, 28672
    v_mov_b32 v28, 0
    v_mov_b32 v29, 0
    ds_write_b64 v26, v[28:29]
    s_waitcnt lgkmcnt(12)
    v_mfma_f32_32x32x16_bf16 v[48:63], v[240:243], v[84:87], v[48:63]
    v_add_u32 v7, 0x8000, v7
    v_add_u32 v11, 0x8000, v11
    ds_read_b128 v[252:255], v7
    ds_read_b64_tr_b16 v[104:105], v11 offset:0
    ds_read_b64_tr_b16 v[106:107], v11 offset:512
    ds_read_b64_tr_b16 v[108:109], v11 offset:1024
    ds_read_b64_tr_b16 v[110:111], v11 offset:1536
    v_mfma_f32_16x16x32_bf16 v[76:79], v[68:71], v[84:87], v[76:79]
    s_waitcnt vmcnt(5)
    s_mov_b32 s3, 0
.Lgr5:
    v_cmp_eq_u32 vcc, s100, v23
    s_add_u32 s3, s3, 1
    s_cmp_eq_u64 vcc, exec
    s_cbranch_scc1 .Lgrok6
    s_cmp_ge_u32 s3, 20000
    s_cbranch_scc1 .Lgrok6
    s_sleep 4
    buffer_load_dwordx2 v[22:23], v21, s[12:15], s52 offen sc1
    s_waitcnt vmcnt(0)
    s_branch .Lgr5
.Lgrok6:
    v_xor_b32 v27, 0x8000, v22
    v_and_b32 v23, 0xffff0000, v22
    s_mov_b32 s48, 0x01000100
    v_rcp_f32 v21, v23
    v_perm_b32 v26, v27, v27, s48
    v_mov_b32 v29, v27
    v_mov_b32 v28, v26
    v_mul_f32 v24, 0x3fb8aa3b, v21
    s_waitcnt lgkmcnt(14)
    v_mfma_f32_32x32x16_bf16 v[32:47], v[88:91], v[244:247], v[32:47]
    v_mfma_f32_16x16x32_bf16 v[76:79], v[64:67], v[88:91], v[76:79]
    v_and_b32 v22, 15, v1
    s_cmp_eq_u32 s96, 0
    v_lshlrev_b32 v22, 3, v22
    s_cselect_b32 s63, s56, 0x20000000
    v_add_u32 v22, 4096, v22
    buffer_load_dword v22, v22, s[12:15], s63 offen sc1
    s_waitcnt lgkmcnt(12)
    v_mfma_f32_32x32x16_bf16 v[48:63], v[244:247], v[92:95], v[48:63]
    v_mfma_f32_16x16x32_bf16 v[76:79], v[68:71], v[92:95], v[76:79]
    v_cvt_pk_bf16_f32 v6, v21, v21
    v_and_b32 v6, 0xffff0000, v6
    v_sub_f32 v7, v21, v6
    v_cvt_pk_bf16_f32 v4, v21, v7
    v_and_b32 v6, 0xffff0000, v4
    v_sub_f32 v7, v7, v6
    v_cvt_pk_bf16_f32 v5, v7, 0
    v_mov_b32 v6, 0
    v_mov_b32 v7, 0
    v_and_b32 v8, 0x3f803f80, v20
    v_mov_b32 v10, 0
    v_mov_b32 v11, 0
    v_mov_b32 v9, v8
    s_add_u32 m0, s96, 8192
    s_lshl_b32 s63, s65, 4
    buffer_load_dwordx4 v16, s[20:23], s63 offen lds
    s_waitcnt lgkmcnt(9)
    v_mfma_f32_32x32x16_bf16 v[32:47], v[96:99], v[248:251], v[32:47]
    v_mfma_f32_16x16x32_bf16 v[76:79], v[64:67], v[96:99], v[76:79]
    s_waitcnt vmcnt(3)
    s_waitcnt lgkmcnt(5)
    s_barrier
    v_mfma_f32_32x32x16_bf16 v[48:63], v[248:251], v[100:103], v[48:63]
    v_mfma_f32_16x16x32_bf16 v[76:79], v[68:71], v[100:103], v[76:79]
    ds_read_b32 v72, v18 offset:6144
    ds_read_b32 v73, v18 offset:6400
    ds_read_b32 v74, v18 offset:6656
    ds_read_b32 v75, v18 offset:6912
    s_waitcnt lgkmcnt(6)
    v_mfma_f32_32x32x16_bf16 v[32:47], v[104:107], v[252:255], v[32:47]
    v_mfma_f32_16x16x32_bf16 v[76:79], v[64:67], v[104:107], v[76:79]
    s_waitcnt lgkmcnt(4)
    v_mfma_f32_32x32x16_bf16 v[48:63], v[252:255], v[108:111], v[48:63]
    v_mfma_f32_16x16x32_bf16 v[76:79], v[68:71], v[108:111], v[76:79]
    s_add_u32 m0, s96, 16384
    s_lshl_b32 s63, s66, 4
    buffer_load_dwordx4 v16, s[20:23], s63 offen lds
    v_mfma_f32_32x32x16_bf16 v[96:111], v[4:7], v[8:11], 0
    s_waitcnt lgkmcnt(0)
    v_add_f32 v72, v72, v73
    v_add_f32 v74, v74, v75
    v_mov_b32 v82, 0
    v_mov_b32 v83, 0
    v_add_f32 v72, v72, v74
    s_nop 1
    v_add_f32 v72, v72, v76
    v_cvt_pk_bf16_f32 v73, v72, v72
    v_and_b32 v73, 0xffff0000, v73
    v_sub_f32 v74, v72, v73
    v_cvt_pk_bf16_f32 v84, v72, v74
    v_and_b32 v73, 0xffff0000, v84
    v_sub_f32 v74, v74, v73
    v_cvt_pk_bf16_f32 v85, v74, 0
    v_and_b32 v80, v20, v84
    v_and_b32 v81, v20, v85
    v_xor_b32 v84, v80, v84
    v_xor_b32 v85, v81, v85
    v_mfma_f32_32x32x16_bf16 v[32:47], v[80:83], v[26:29], v[32:47]
    s_nop 0
    v_mfma_f32_32x32x16_bf16 v[48:63], v[26:29], v[82:85], v[48:63]
    s_barrier
    s_nop 8
    v_cvt_pk_bf16_f32 v80, v32, v33
    v_cvt_pk_bf16_f32 v81, v34, v35
    v_cvt_pk_bf16_f32 v82, v36, v37
    v_cvt_pk_bf16_f32 v83, v38, v39
    v_cvt_pk_bf16_f32 v84, v40, v41
    v_cvt_pk_bf16_f32 v85, v42, v43
    v_cvt_pk_bf16_f32 v86, v44, v45
    v_cvt_pk_bf16_f32 v87, v46, v47
    v_mfma_f32_32x32x16_bf16 v[32:47], v[112:115], v[80:83], 0
    s_nop 0
    v_mfma_f32_32x32x16_bf16 v[32:47], v[116:119], v[84:87], v[32:47]
    v_mul_f32 v48, v48, v96
    v_mul_f32 v49, v49, v97
    v_mul_f32 v50, v50, v98
    v_mul_f32 v51, v51, v99
    v_mul_f32 v52, v52, v100
    v_mul_f32 v53, v53, v101
    v_mul_f32 v54, v54, v102
    v_mul_f32 v55, v55, v103
    v_mul_f32 v56, v56, v104
    v_mul_f32 v57, v57, v105
    v_mul_f32 v58, v58, v106
    v_mul_f32 v59, v59, v107
    v_mul_f32 v60, v60, v108
    v_mul_f32 v61, v61, v109
    v_mul_f32 v62, v62, v110
    v_mul_f32 v63, v63, v111
    v_cvt_pk_bf16_f32 v104, v48, v49
    v_cvt_pk_bf16_f32 v105, v50, v51
    v_cvt_pk_bf16_f32 v106, v52, v53
    v_cvt_pk_bf16_f32 v107, v54, v55
    v_cvt_pk_bf16_f32 v108, v56, v57
    v_cvt_pk_bf16_f32 v109, v58, v59
    v_cvt_pk_bf16_f32 v110, v60, v61
    v_cvt_pk_bf16_f32 v111, v62, v63
    v_max3_f32 v4, v32, v33, v34
    v_min3_f32 v6, v32, v33, v34
    v_max3_f32 v4, v4, v35, v36
    v_min3_f32 v6, v6, v35, v36
    v_max3_f32 v4, v4, v37, v38
    v_min3_f32 v6, v6, v37, v38
    v_max_f32 v4, v4, v39
    v_min_f32 v6, v6, v39
    v_max3_f32 v5, v40, v41, v42
    v_min3_f32 v7, v40, v41, v42
    v_max3_f32 v5, v5, v43, v44
    v_min3_f32 v7, v7, v43, v44
    v_max3_f32 v5, v5, v45, v46
    v_min3_f32 v7, v7, v45, v46
    v_max_f32 v5, v5, v47
    v_min_f32 v7, v7, v47
    s_nop 0
    v_permlane32_swap_b32 v4, v5
    v_permlane32_swap_b32 v6, v7
    ds_read_b64_tr_b16 v[72:73], v12 offset:0
    ds_read_b64_tr_b16 v[74:75], v12 offset:512
    ds_read_b64_tr_b16 v[76:77], v12 offset:8192
    ds_read_b64_tr_b16 v[78:79], v12 offset:8704
    v_max_f32 v4, v4, v5
    v_min_f32 v6, v6, v7
    v_mul_f32 v4, v4, v24
    v_mul_f32 v6, v6, v24
    v_mov_b32 v5, v4
    v_mov_b32 v7, v6
    s_nop 0
    v_permlane32_swap_b32 v4, v5
    v_permlane32_swap_b32 v6, v7
    v_fma_f32 v48, v32, v24, -v4
    v_fma_f32 v32, -v32, v24, v6
    v_fma_f32 v49, v33, v24, -v4
    v_fma_f32 v33, -v33, v24, v6
    v_fma_f32 v50, v34, v24, -v4
    v_fma_f32 v34, -v34, v24, v6
    v_fma_f32 v51, v35, v24, -v4
    v_fma_f32 v35, -v35, v24, v6
    s_waitcnt lgkmcnt(0)
    v_mfma_f32_16x16x32_bf16 v[68:71], v[64:67], v[72:75], 0
    v_mfma_f32_16x16x32_bf16 v[68:71], v[64:67], v[76:79], v[68:71]
    ds_read_b64_tr_b16 v[72:73], v12 offset:16384
    ds_read_b64_tr_b16 v[74:75], v12 offset:16896
    ds_read_b64_tr_b16 v[76:77], v12 offset:24576
    ds_read_b64_tr_b16 v[78:79], v12 offset:25088
    v_fma_f32 v52, v36, v24, -v4
    v_fma_f32 v36, -v36, v24, v6
    v_fma_f32 v53, v37, v24, -v4
    v_fma_f32 v37, -v37, v24, v6
    v_fma_f32 v54, v38, v24, -v4
    v_fma_f32 v38, -v38, v24, v6
    v_fma_f32 v55, v39, v24, -v4
    v_fma_f32 v39, -v39, v24, v6
    v_fma_f32 v56, v40, v24, -v5
    v_fma_f32 v40, -v40, v24, v7
    v_fma_f32 v57, v41, v24, -v5
    v_fma_f32 v41, -v41, v24, v7
    v_fma_f32 v58, v42, v24, -v5
    v_fma_f32 v42, -v42, v24, v7
    v_fma_f32 v59, v43, v24, -v5
    v_fma_f32 v43, -v43, v24, v7
    s_add_u32 m0, s96, 32768
    s_lshl_b32 s63, s67, 4
    buffer_load_dwordx4 v16, s[20:23], s63 offen lds
    v_fma_f32 v60, v44, v24, -v5
    v_fma_f32 v44, -v44, v24, v7
    v_fma_f32 v61, v45, v24, -v5
    v_fma_f32 v45, -v45, v24, v7
    v_fma_f32 v62, v46, v24, -v5
    v_fma_f32 v46, -v46, v24, v7
    v_fma_f32 v63, v47, v24, -v5
    v_fma_f32 v47, -v47, v24, v7
    v_exp_f32 v48, v48
    v_exp_f32 v32, v32
    v_exp_f32 v49, v49
    v_exp_f32 v33, v33
    v_exp_f32 v50, v50
    v_exp_f32 v34, v34
    v_exp_f32 v51, v51
    s_waitcnt lgkmcnt(0)
    v_mfma_f32_16x16x32_bf16 v[68:71], v[64:67], v[72:75], v[68:71]
    v_mfma_f32_16x16x32_bf16 v[68:71], v[64:67], v[76:79], v[68:71]
    ds_read_b64_tr_b16 v[72:73], v12 offset:32768
    ds_read_b64_tr_b16 v[74:75], v12 offset:33280
    ds_read_b64_tr_b16 v[76:77], v12 offset:40960
    ds_read_b64_tr_b16 v[78:79], v12 offset:41472
    v_exp_f32 v35, v35
    v_exp_f32 v52, v52
    v_exp_f32 v36, v36
    v_exp_f32 v53, v53
    v_exp_f32 v37, v37
    v_exp_f32 v54, v54
    v_exp_f32 v38, v38
    v_exp_f32 v55, v55
    v_exp_f32 v39, v39
    v_exp_f32 v56, v56
    v_exp_f32 v40, v40
    v_exp_f32 v57, v57
    v_exp_f32 v41, v41
    v_exp_f32 v58, v58
    v_exp_f32 v42, v42
    v_exp_f32 v59, v59
    s_add_u32 m0, s96, 40960
    s_lshl_b32 s63, s68, 4
    buffer_load_dwordx4 v16, s[20:23], s63 offen lds
    v_exp_f32 v43, v43
    v_exp_f32 v60, v60
    v_exp_f32 v44, v44
    v_exp_f32 v61, v61
    v_exp_f32 v45, v45
    v_exp_f32 v62, v62
    v_exp_f32 v46, v46
    v_exp_f32 v63, v63
    v_exp_f32 v47, v47
    v_add_f32 v8, v48, v49
    v_add_f32 v10, v32, v33
    v_add_f32 v9, v56, v57
    v_add_f32 v11, v40, v41
    v_add_f32 v8, v8, v50
    v_add_f32 v10, v10, v34
    v_add_f32 v9, v9, v58
    s_waitcnt lgkmcnt(0)
    v_mfma_f32_16x16x32_bf16 v[68:71], v[64:67], v[72:75], v[68:71]
    v_mfma_f32_16x16x32_bf16 v[68:71], v[64:67], v[76:79], v[68:71]
    ds_read_b64_tr_b16 v[72:73], v12 offset:49152
    ds_read_b64_tr_b16 v[74:75], v12 offset:49664
    ds_read_b64_tr_b16 v[76:77], v12 offset:57344
    ds_read_b64_tr_b16 v[78:79], v12 offset:57856
    v_add_f32 v11, v11, v42
    v_add_f32 v8, v8, v51
    v_add_f32 v10, v10, v35
    v_add_f32 v9, v9, v59
    v_add_f32 v11, v11, v43
    v_add_f32 v8, v8, v52
    v_add_f32 v10, v10, v36
    v_add_f32 v9, v9, v60
    v_add_f32 v11, v11, v44
    v_add_f32 v8, v8, v53
    v_add_f32 v10, v10, v37
    v_add_f32 v9, v9, v61
    v_add_f32 v11, v11, v45
    v_add_f32 v8, v8, v54
    v_add_f32 v10, v10, v38
    v_add_f32 v9, v9, v62
    s_waitcnt lgkmcnt(0)
    v_mfma_f32_16x16x32_bf16 v[68:71], v[64:67], v[72:75], v[68:71]
    v_mfma_f32_16x16x32_bf16 v[68:71], v[64:67], v[76:79], v[68:71]
    v_add_f32 v11, v11, v46
    v_add_f32 v8, v8, v55
    v_add_f32 v10, v10, v39
    v_add_f32 v9, v9, v63
    v_add_f32 v11, v11, v47
    s_nop 0
    v_permlane32_swap_b32 v8, v9
    v_permlane32_swap_b32 v10, v11
    v_add_f32 v8, v8, v9
    v_add_f32 v10, v10, v11
    v_rcp_f32 v8, v8
    v_rcp_f32 v10, v10
    v_mov_b32 v9, v8
    v_mov_b32 v11, v10
    s_nop 0
    v_permlane32_swap_b32 v8, v9
    v_permlane32_swap_b32 v10, v11
    ds_write_b32 v17, v68 offset:0
    v_mul_f32 v48, v48, v8
    v_mul_f32 v32, v32, v10
    v_mul_f32 v49, v49, v8
    v_mul_f32 v33, v33, v10
    v_mul_f32 v50, v50, v8
    v_mul_f32 v34, v34, v10
    v_mul_f32 v51, v51, v8
    v_mul_f32 v35, v35, v10
    v_mul_f32 v52, v52, v8
    v_mul_f32 v36, v36, v10
    v_mul_f32 v53, v53, v8
    v_mul_f32 v37, v37, v10
    v_mul_f32 v54, v54, v8
    v_mul_f32 v38, v38, v10
    v_mul_f32 v55, v55, v8
    v_mul_f32 v39, v39, v10
    v_mul_f32 v56, v56, v9
    v_mul_f32 v40, v40, v11
    v_mul_f32 v57, v57, v9
    v_mul_f32 v41, v41, v11
    v_mul_f32 v58, v58, v9
    v_mul_f32 v42, v42, v11
    v_mul_f32 v59, v59, v9
    v_mul_f32 v43, v43, v11
    v_mul_f32 v60, v60, v9
    v_mul_f32 v44, v44, v11
    v_mul_f32 v61, v61, v9
    v_mul_f32 v45, v45, v11
    v_mul_f32 v62, v62, v9
    v_mul_f32 v46, v46, v11
    v_mul_f32 v63, v63, v9
    v_mul_f32 v47, v47, v11
    v_cvt_pk_bf16_f32 v80, v48, v49
    v_cvt_pk_bf16_f32 v81, v50, v51
    v_cvt_pk_bf16_f32 v82, v52, v53
    v_cvt_pk_bf16_f32 v83, v54, v55
    v_cvt_pk_bf16_f32 v84, v32, v33
    v_cvt_pk_bf16_f32 v85, v34, v35
    v_cvt_pk_bf16_f32 v86, v36, v37
    v_cvt_pk_bf16_f32 v87, v38, v39
    s_waitcnt lgkmcnt(0)
    v_mfma_f32_32x32x16_bf16 v[64:79], v[80:83], v[120:123], 0
    v_mfma_f32_32x32x16_bf16 v[64:79], v[84:87], v[124:127], v[64:79]
    v_cvt_pk_bf16_f32 v88, v56, v57
    v_cvt_pk_bf16_f32 v89, v58, v59
    v_cvt_pk_bf16_f32 v90, v60, v61
    v_cvt_pk_bf16_f32 v91, v62, v63
    v_cvt_pk_bf16_f32 v92, v40, v41
    v_cvt_pk_bf16_f32 v93, v42, v43
    v_cvt_pk_bf16_f32 v94, v44, v45
    v_cvt_pk_bf16_f32 v95, v46, v47
    v_mfma_f32_32x32x16_bf16 v[48:63], v[88:91], v[120:123], 0
    s_nop 0
    v_mfma_f32_32x32x16_bf16 v[48:63], v[92:95], v[124:127], v[48:63]
    v_lshrrev_b32 v23, 4, v2
    v_add_u32 v23, -1, v23
    v_and_b32 v96, v23, v104
    v_and_b32 v97, v23, v105
    v_and_b32 v98, v23, v106
    v_and_b32 v99, v23, v107
    v_and_b32 v100, v23, v108
    v_and_b32 v101, v23, v109
    v_and_b32 v102, v23, v110
    v_and_b32 v103, v23, v111
    v_cvt_pk_bf16_f32 v80, v64, v65
    v_cvt_pk_bf16_f32 v81, v66, v67
    v_cvt_pk_bf16_f32 v82, v68, v69
    v_cvt_pk_bf16_f32 v83, v70, v71
    v_cvt_pk_bf16_f32 v84, v72, v73
    v_cvt_pk_bf16_f32 v85, v74, v75
    v_cvt_pk_bf16_f32 v86, v76, v77
    v_cvt_pk_bf16_f32 v87, v78, v79
    v_mfma_f32_32x32x16_bf16 v[32:47], v[80:83], v[96:99], 0
    s_nop 0
    v_mfma_f32_32x32x16_bf16 v[32:47], v[84:87], v[100:103], v[32:47]
    v_xor_b32 v104, v96, v104
    v_xor_b32 v105, v97, v105
    v_xor_b32 v106, v98, v106
    v_xor_b32 v107, v99, v107
    v_xor_b32 v108, v100, v108
    v_xor_b32 v109, v101, v109
    v_xor_b32 v110, v102, v110
    v_xor_b32 v111, v103, v111
    v_cvt_pk_bf16_f32 v88, v48, v49
    v_cvt_pk_bf16_f32 v89, v50, v51
    v_cvt_pk_bf16_f32 v90, v52, v53
    v_cvt_pk_bf16_f32 v91, v54, v55
    v_cvt_pk_bf16_f32 v92, v56, v57
    v_cvt_pk_bf16_f32 v93, v58, v59
    v_cvt_pk_bf16_f32 v94, v60, v61
    v_cvt_pk_bf16_f32 v95, v62, v63
    v_mfma_f32_32x32x16_bf16 v[32:47], v[88:91], v[104:107], v[32:47]
    s_nop 0
    v_mfma_f32_32x32x16_bf16 v[32:47], v[92:95], v[108:111], v[32:47]
    s_lshl_b32 s48, s96, 2
    s_add_u32 s48, s48, 65536
    v_add_u32 v8, s48, v30
    s_and_b32 s49, s96, 0xc00
    s_lshl_b32 s48, s98, 14
    s_add_u32 s48, s48, s49
    s_add_u32 s48, s48, 65536
    v_lshl_add_u32 v4, v1, 2, s48
    s_lshr_b32 s50, s49, 4
    s_add_u32 s48, s50, 2048
    v_add_u32 v7, s48, v18
    v_add_f32 v64, v64, v65
    v_add_f32 v66, v66, v67
    v_add_f32 v68, v68, v69
    v_add_f32 v70, v70, v71
    v_add_f32 v72, v72, v73
    v_add_f32 v74, v74, v75
    v_add_f32 v76, v76, v77
    v_add_f32 v78, v78, v79
    v_add_f32 v64, v64, v66
    v_add_f32 v68, v68, v70
    v_add_f32 v72, v72, v74
    v_add_f32 v76, v76, v78
    v_add_f32 v64, v64, v68
    v_add_f32 v72, v72, v76
    v_add_f32 v64, v64, v72
    v_add_f32 v48, v48, v49
    v_add_f32 v50, v50, v51
    v_add_f32 v52, v52, v53
    ds_write_b128 v8, v[32:35] offset:0
    v_add_f32 v54, v54, v55
    v_add_f32 v56, v56, v57
    v_add_f32 v58, v58, v59
    v_add_f32 v60, v60, v61
    ds_write_b128 v8, v[36:39] offset:1024
    v_add_f32 v62, v62, v63
    v_add_f32 v48, v48, v50
    v_add_f32 v52, v52, v54
    v_add_f32 v56, v56, v58
    ds_write_b128 v8, v[40:43] offset:2048
    v_add_f32 v60, v60, v62
    v_add_f32 v48, v48, v52
    v_add_f32 v56, v56, v60
    v_add_f32 v48, v48, v56
    ds_write_b128 v8, v[44:47] offset:3072
    s_nop 0
    v_permlane32_swap_b32 v64, v48
    v_add_f32 v64, v64, v48
    ds_write_b32 v17, v64 offset:2048
    v_lshlrev_b32 v5, 2, v1
    v_cmp_gt_u32 vcc, 16, v1
    v_mov_b32 v6, 0x20000000
    s_add_u32 s50, s50, s53
    s_add_u32 s53, s53, s49
    v_cndmask_b32_e64 v6, v6, v5, vcc
    s_add_u32 s50, s50, 4096
    s_cmp_lg_u32 s96, 0
    s_cbranch_scc1 .Lzok8
    s_mov_b32 s3, 0
    s_waitcnt vmcnt(4)
.Lzc7:
    v_cmp_eq_u32 vcc, s100, v22
    s_add_u32 s3, s3, 1
    s_cmp_eq_u64 vcc, exec
    s_cbranch_scc1 .Lzok8
    s_cmp_ge_u32 s3, 20000
    s_cbranch_scc1 .Lzok8
    v_and_b32 v22, 15, v1
    s_cmp_eq_u32 s96, 0
    v_lshlrev_b32 v22, 3, v22
    s_cselect_b32 s63, s56, 0x20000000
    v_add_u32 v22, 4096, v22
    buffer_load_dword v22, v22, s[12:15], s63 offen sc1
    s_waitcnt vmcnt(0)
    s_branch .Lzc7
.Lzok8:
    s_waitcnt lgkmcnt(0)
    s_barrier
    ds_read2st64_b32 v[48:49], v4 offset0:0 offset1:16
    ds_read2st64_b32 v[50:51], v4 offset0:32 offset1:48
    ds_read2st64_b32 v[52:53], v4 offset0:1 offset1:17
    ds_read2st64_b32 v[54:55], v4 offset0:33 offset1:49
    ds_read2st64_b32 v[56:57], v4 offset0:2 offset1:18
    ds_read2st64_b32 v[58:59], v4 offset0:34 offset1:50
    ds_read2st64_b32 v[60:61], v4 offset0:3 offset1:19
    ds_read2st64_b32 v[62:63], v4 offset0:35 offset1:51
    ds_read2st64_b32 v[64:65], v7 offset0:0 offset1:1
    ds_read2st64_b32 v[66:67], v7 offset0:2 offset1:3
    ds_read_b32 v32, v18 offset:0
    ds_read_b32 v33, v18 offset:256
    ds_read_b32 v34, v18 offset:512
    ds_read_b32 v35, v18 offset:768
    s_waitcnt lgkmcnt(12)
    v_add_f32 v48, v48, v49
    v_add_f32 v50, v50, v51
    v_add_f32 v48, v48, v50
    buffer_atomic_add_f32 v48, v5, s[12:15], s53 offen offset:0
    s_waitcnt lgkmcnt(10)
    v_add_f32 v52, v52, v53
    v_add_f32 v54, v54, v55
    v_add_f32 v52, v52, v54
    buffer_atomic_add_f32 v52, v5, s[12:15], s53 offen offset:256
    s_waitcnt lgkmcnt(8)
    v_add_f32 v56, v56, v57
    v_add_f32 v58, v58, v59
    v_add_f32 v56, v56, v58
    buffer_atomic_add_f32 v56, v5, s[12:15], s53 offen offset:512
    s_waitcnt lgkmcnt(6)
    v_add_f32 v60, v60, v61
    v_add_f32 v62, v62, v63
    v_add_f32 v60, v60, v62
    buffer_atomic_add_f32 v60, v5, s[12:15], s53 offen offset:768
    s_waitcnt lgkmcnt(4)
    v_add_f32 v64, v64, v65
    v_add_f32 v66, v66, v67
    v_add_f32 v64, v64, v66
    buffer_atomic_add_f32 v64, v6, s[12:15], s50 offen
    v_and_b32 v0, v20, v0
    v_mul_f32 v24, 0.5, v21
    v_mul_f32 v24, v24, v24
    s_waitcnt lgkmcnt(0)
    v_add_f32 v32, v32, v33
    v_add_f32 v34, v34, v35
    v_mov_b32 v38, 0
    v_mov_b32 v39, 0
    v_add_f32 v32, v32, v34
    v_cvt_pk_bf16_f32 v33, v32, v32
    v_and_b32 v33, 0xffff0000, v33
    v_sub_f32 v34, v32, v33
    v_cvt_pk_bf16_f32 v36, v32, v34
    v_and_b32 v33, 0xffff0000, v36
    v_sub_f32 v34, v34, v33
    v_cvt_pk_bf16_f32 v37, v34, v0
    s_barrier
    s_lshl_b32 s48, s98, 2
    s_add_u32 s48, s48, s99
    s_cmp_ge_u32 s48, 7
    s_cselect_b32 s48, s98, 0
    s_cmp_lg_u32 s48, 0
    s_cbranch_scc1 .Lsk9
    ds_read_b64_tr_b16 v[80:81], v12 offset:0
    ds_read_b64_tr_b16 v[82:83], v12 offset:512
    ds_read_b64_tr_b16 v[84:85], v13 offset:0
    ds_read_b64_tr_b16 v[86:87], v13 offset:512
    ds_read_b64_tr_b16 v[88:89], v14 offset:0
    ds_read_b64_tr_b16 v[90:91], v14 offset:512
    ds_read_b64_tr_b16 v[92:93], v15 offset:0
    ds_read_b64_tr_b16 v[94:95], v15 offset:512
    ds_read_b64_tr_b16 v[96:97], v12 offset:8192
    ds_read_b64_tr_b16 v[98:99], v12 offset:8704
    ds_read_b64_tr_b16 v[100:101], v13 offset:8192
    ds_read_b64_tr_b16 v[102:103], v13 offset:8704
    v_mfma_f32_32x32x16_bf16 v[64:79], v[36:39], v[26:29], 0
    s_waitcnt lgkmcnt(8)
    v_mfma_f32_32x32x16_bf16 v[64:79], v[80:83], v[128:131], v[64:79]
    ds_read_b64_tr_b16 v[104:105], v14 offset:8192
    ds_read_b64_tr_b16 v[106:107], v14 offset:8704
    v_mfma_f32_32x32x16_bf16 v[64:79], v[84:87], v[132:135], v[64:79]
    ds_read_b64_tr_b16 v[108:109], v15 offset:8192
    ds_read_b64_tr_b16 v[110:111], v15 offset:8704
    s_waitcnt lgkmcnt(8)
    v_mfma_f32_32x32x16_bf16 v[64:79], v[88:91], v[136:139], v[64:79]
    ds_read_b64_tr_b16 v[80:81], v12 offset:16384
    ds_read_b64_tr_b16 v[82:83], v12 offset:16896
    v_mfma_f32_32x32x16_bf16 v[64:79], v[92:95], v[140:143], v[64:79]
    ds_read_b64_tr_b16 v[84:85], v13 offset:16384
    ds_read_b64_tr_b16 v[86:87], v13 offset:16896
    s_waitcnt lgkmcnt(8)
    v_mfma_f32_32x32x16_bf16 v[64:79], v[96:99], v[144:147], v[64:79]
    ds_read_b64_tr_b16 v[88:89], v14 offset:16384
    ds_read_b64_tr_b16 v[90:91], v14 offset:16896
    v_mfma_f32_32x32x16_bf16 v[64:79], v[100:103], v[148:151], v[64:79]
    ds_read_b64_tr_b16 v[92:93], v15 offset:16384
    ds_read_b64_tr_b16 v[94:95], v15 offset:16896
    s_waitcnt lgkmcnt(8)
    v_mfma_f32_32x32x16_bf16 v[64:79], v[104:107], v[152:155], v[64:79]
    ds_read_b64_tr_b16 v[96:97], v12 offset:24576
    ds_read_b64_tr_b16 v[98:99], v12 offset:25088
    v_mfma_f32_32x32x16_bf16 v[64:79], v[108:111], v[156:159], v[64:79]
    ds_read_b64_tr_b16 v[100:101], v13 offset:24576
    ds_read_b64_tr_b16 v[102:103], v13 offset:25088
    s_waitcnt lgkmcnt(8)
    v_mfma_f32_32x32x16_bf16 v[64:79], v[80:83], v[160:163], v[64:79]
    ds_read_b64_tr_b16 v[104:105], v14 offset:24576
    ds_read_b64_tr_b16 v[106:107], v14 offset:25088
    v_mfma_f32_32x32x16_bf16 v[64:79], v[84:87], v[164:167], v[64:79]
    ds_read_b64_tr_b16 v[108:109], v15 offset:24576
    ds_read_b64_tr_b16 v[110:111], v15 offset:25088
    s_waitcnt lgkmcnt(8)
    v_mfma_f32_32x32x16_bf16 v[64:79], v[88:91], v[168:171], v[64:79]
    ds_read_b64_tr_b16 v[80:81], v12 offset:32768
    ds_read_b64_tr_b16 v[82:83], v12 offset:33280
    v_mfma_f32_32x32x16_bf16 v[64:79], v[92:95], v[172:175], v[64:79]
    ds_read_b64_tr_b16 v[84:85], v13 offset:32768
    ds_read_b64_tr_b16 v[86:87], v13 offset:33280
    s_waitcnt lgkmcnt(8)
    v_mfma_f32_32x32x16_bf16 v[64:79], v[96:99], v[176:179], v[64:79]
    ds_read_b64_tr_b16 v[88:89], v14 offset:32768
    ds_read_b64_tr_b16 v[90:91], v14 offset:33280
    v_mfma_f32_32x32x16_bf16 v[64:79], v[100:103], v[180:183], v[64:79]
    ds_read_b64_tr_b16 v[92:93], v15 offset:32768
    ds_read_b64_tr_b16 v[94:95], v15 offset:33280
    s_waitcnt lgkmcnt(8)
    v_mfma_f32_32x32x16_bf16 v[64:79], v[104:107], v[184:187], v[64:79]
    ds_read_b64_tr_b16 v[96:97], v12 offset:40960
    ds_read_b64_tr_b16 v[98:99], v12 offset:41472
    v_mfma_f32_32x32x16_bf16 v[64:79], v[108:111], v[188:191], v[64:79]
    ds_read_b64_tr_b16 v[100:101], v13 offset:40960
    ds_read_b64_tr_b16 v[102:103], v13 offset:41472
    v_mov_b32 v22, 28672
    v_mov_b32 v23, 1
    s_waitcnt vmcnt(0)
    s_mov_b64 exec, 1
    ds_add_rtn_u32 v22, v22, v23
    s_mov_b64 exec, -1
    s_waitcnt lgkmcnt(9)
    v_mfma_f32_32x32x16_bf16 v[64:79], v[80:83], v[192:195], v[64:79]
    ds_read_b64_tr_b16 v[104:105], v14 offset:40960
    ds_read_b64_tr_b16 v[106:107], v14 offset:41472
    v_mfma_f32_32x32x16_bf16 v[64:79], v[84:87], v[196:199], v[64:79]
    ds_read_b64_tr_b16 v[108:109], v15 offset:40960
    ds_read_b64_tr_b16 v[110:111], v15 offset:41472
    s_waitcnt lgkmcnt(9)
    v_mfma_f32_32x32x16_bf16 v[64:79], v[88:91], v[200:203], v[64:79]
    ds_read_b64_tr_b16 v[80:81], v12 offset:49152
    ds_read_b64_tr_b16 v[82:83], v12 offset:49664
    s_waitcnt lgkmcnt(6)
    v_readfirstlane_b32 s48, v22
    s_nop 0
    s_cmp_lg_u32 s48, 7
    s_cbranch_scc1 .Lkf11
    v_mov_b32 v40, s100
    v_mov_b32 v41, s101
    buffer_store_dwordx2 v[40:41], v25, s[12:15], s55 offen sc1
.Lkf11:
    v_mfma_f32_32x32x16_bf16 v[64:79], v[92:95], v[204:207], v[64:79]
    ds_read_b64_tr_b16 v[84:85], v13 offset:49152
    ds_read_b64_tr_b16 v[86:87], v13 offset:49664
    v_mfma_f32_32x32x16_bf16 v[64:79], v[96:99], v[208:211], v[64:79]
    ds_read_b64_tr_b16 v[88:89], v14 offset:49152
    ds_read_b64_tr_b16 v[90:91], v14 offset:49664
    v_mfma_f32_32x32x16_bf16 v[64:79], v[100:103], v[212:215], v[64:79]
    ds_read_b64_tr_b16 v[92:93], v15 offset:49152
    ds_read_b64_tr_b16 v[94:95], v15 offset:49664
    s_add_u32 m0, s96, 49152
    s_lshl_b32 s63, s69, 4
    buffer_load_dwordx4 v16, s[20:23], s63 offen lds
    s_waitcnt lgkmcnt(8)
    v_mfma_f32_32x32x16_bf16 v[64:79], v[104:107], v[216:219], v[64:79]
    ds_read_b64_tr_b16 v[96:97], v12 offset:57344
    ds_read_b64_tr_b16 v[98:99], v12 offset:57856
    v_mfma_f32_32x32x16_bf16 v[64:79], v[108:111], v[220:223], v[64:79]
    ds_read_b64_tr_b16 v[100:101], v13 offset:57344
    ds_read_b64_tr_b16 v[102:103], v13 offset:57856
    s_add_u32 m0, s96, 57344
    s_lshl_b32 s63, s70, 4
    buffer_load_dwordx4 v16, s[20:23], s63 offen lds
    s_waitcnt lgkmcnt(8)
    v_mfma_f32_32x32x16_bf16 v[64:79], v[80:83], v[224:227], v[64:79]
    ds_read_b64_tr_b16 v[104:105], v14 offset:57344
    ds_read_b64_tr_b16 v[106:107], v14 offset:57856
    v_mfma_f32_32x32x16_bf16 v[64:79], v[84:87], v[228:231], v[64:79]
    ds_read_b64_tr_b16 v[108:109], v15 offset:57344
    ds_read_b64_tr_b16 v[110:111], v15 offset:57856
    s_add_u32 m0, s96, 65536
    s_lshl_b32 s63, s71, 4
    buffer_load_dwordx4 v16, s[20:23], s63 offen lds
    s_waitcnt lgkmcnt(8)
    v_mfma_f32_32x32x16_bf16 v[64:79], v[88:91], v[232:235], v[64:79]
    v_mfma_f32_32x32x16_bf16 v[64:79], v[92:95], v[236:239], v[64:79]
    s_add_u32 m0, s96, 73728
    s_lshl_b32 s63, s72, 4
    buffer_load_dwordx4 v16, s[20:23], s63 offen lds
    s_waitcnt lgkmcnt(4)
    v_mfma_f32_32x32x16_bf16 v[64:79], v[96:99], v[240:243], v[64:79]
    v_mfma_f32_32x32x16_bf16 v[64:79], v[100:103], v[244:247], v[64:79]
    s_add_u32 m0, s96, 81920
    s_lshl_b32 s63, s73, 4
    buffer_load_dwordx4 v16, s[20:23], s63 offen lds
    s_waitcnt lgkmcnt(0)
    v_mfma_f32_32x32x16_bf16 v[64:79], v[104:107], v[248:251], v[64:79]
    v_mfma_f32_32x32x16_bf16 v[64:79], v[108:111], v[252:255], v[64:79]
    s_add_u32 m0, s96, 90112
    s_lshl_b32 s63, s74, 4
    buffer_load_dwordx4 v16, s[20:23], s63 offen lds
    v_bfe_u32 v8, v1, 2, 2
    s_and_b32 s48, s96, 0x1800
    v_lshl_add_u32 v9, v8, 7, s48
    v_lshrrev_b32 v8, 1, v8
    v_lshl_add_u32 v9, v8, 6, v9
    v_bfe_u32 v8, v1, 4, 1
    v_lshl_add_u32 v9, v8, 5, v9
    v_and_b32 v8, 3, v1
    v_lshl_add_u32 v9, v8, 3, v9
    v_lshl_add_u32 v4, v3, 9, v9
    v_xor_b32 v5, 64, v4
    v_add_u32 v6, 0x10000, v4
    v_add_u32 v7, 0x10000, v5
    v_add_u32 v10, 0x20000, v4
    v_add_u32 v11, 0x20000, v5
    v_add_f32_e64 v64, v64, |v64|
    v_add_f32_e64 v65, v65, |v65|
    v_add_f32_e64 v66, v66, |v66|
    v_add_f32_e64 v67, v67, |v67|
    v_add_f32_e64 v68, v68, |v68|
    v_add_f32_e64 v69, v69, |v69|
    v_add_f32_e64 v70, v70, |v70|
    v_add_f32_e64 v71, v71, |v71|
    v_add_f32_e64 v72, v72, |v72|
    v_add_f32_e64 v73, v73, |v73|
    v_add_f32_e64 v74, v74, |v74|
    v_add_f32_e64 v75, v75, |v75|
    v_add_f32_e64 v76, v76, |v76|
    v_add_f32_e64 v77, v77, |v77|
    v_add_f32_e64 v78, v78, |v78|
    v_add_f32_e64 v79, v79, |v79|
    v_mul_f32 v64, v64, v64
    v_mul_f32 v65, v65, v65
    v_mul_f32 v66, v66, v66
    v_mul_f32 v67, v67, v67
    v_mul_f32 v68, v68, v68
    v_mul_f32 v69, v69, v69
    v_mul_f32 v70, v70, v70
    v_mul_f32 v71, v71, v71
    v_mul_f32 v72, v72, v72
    v_mul_f32 v73, v73, v73
    v_mul_f32 v74, v74, v74
    v_mul_f32 v75, v75, v75
    v_mul_f32 v76, v76, v76
    v_mul_f32 v77, v77, v77
    v_mul_f32 v78, v78, v78
    v_mul_f32 v79, v79, v79
    v_mul_f32 v64, v64, v24
    v_mul_f32 v65, v65, v24
    v_mul_f32 v66, v66, v24
    v_mul_f32 v67, v67, v24
    v_mul_f32 v68, v68, v24
    v_mul_f32 v69, v69, v24
    v_mul_f32 v70, v70, v24
    v_mul_f32 v71, v71, v24
    v_mul_f32 v72, v72, v24
    v_mul_f32 v73, v73, v24
    v_mul_f32 v74, v74, v24
    v_mul_f32 v75, v75, v24
    v_mul_f32 v76, v76, v24
    v_mul_f32 v77, v77, v24
    v_mul_f32 v78, v78, v24
    v_mul_f32 v79, v79, v24
    v_cvt_pk_bf16_f32 v80, v64, v65
    v_cvt_pk_bf16_f32 v81, v66, v67
    v_cvt_pk_bf16_f32 v82, v68, v69
    v_cvt_pk_bf16_f32 v83, v70, v71
    v_cvt_pk_bf16_f32 v84, v72, v73
    v_cvt_pk_bf16_f32 v85, v74, v75
    v_cvt_pk_bf16_f32 v86, v76, v77
    v_cvt_pk_bf16_f32 v87, v78, v79
    buffer_store_dwordx4 v[80:83], v30, s[12:15], s51 offen offset:0 sc1
    buffer_store_dwordx4 v[84:87], v30, s[12:15], s51 offen offset:1024 sc1
    s_branch .Lj10
.Lsk9:
    v_bfe_u32 v8, v1, 2, 2
    s_and_b32 s48, s96, 0x1800
    v_lshl_add_u32 v9, v8, 7, s48
    v_lshrrev_b32 v8, 1, v8
    v_lshl_add_u32 v9, v8, 6, v9
    v_bfe_u32 v8, v1, 4, 1
    v_lshl_add_u32 v9, v8, 5, v9
    v_and_b32 v8, 3, v1
    v_lshl_add_u32 v9, v8, 3, v9
    v_lshl_add_u32 v4, v3, 9, v9
    v_xor_b32 v5, 64, v4
    v_add_u32 v6, 0x10000, v4
    v_add_u32 v7, 0x10000, v5
    v_add_u32 v10, 0x20000, v4
    v_add_u32 v11, 0x20000, v5
    v_mov_b32 v22, 28672
    v_mov_b32 v23, 1
    s_waitcnt vmcnt(0)
    s_mov_b64 exec, 1
    ds_add_rtn_u32 v22, v22, v23
    s_mov_b64 exec, -1
    s_waitcnt lgkmcnt(0)
    v_readfirstlane_b32 s48, v22
    s_nop 0
    s_cmp_lg_u32 s48, 7
    s_cbranch_scc1 .Lkf12
    v_mov_b32 v40, s100
    v_mov_b32 v41, s101
    buffer_store_dwordx2 v[40:41], v25, s[12:15], s55 offen sc1
.Lkf12:
    s_add_u32 m0, s96, 49152
    s_lshl_b32 s63, s69, 4
    buffer_load_dwordx4 v16, s[20:23], s63 offen lds
    s_add_u32 m0, s96, 57344
    s_lshl_b32 s63, s70, 4
    buffer_load_dwordx4 v16, s[20:23], s63 offen lds
    s_add_u32 m0, s96, 65536
    s_lshl_b32 s63, s71, 4
    buffer_load_dwordx4 v16, s[20:23], s63 offen lds
    s_add_u32 m0, s96, 73728
    s_lshl_b32 s63, s72, 4
    buffer_load_dwordx4 v16, s[20:23], s63 offen lds
    s_add_u32 m0, s96, 81920
    s_lshl_b32 s63, s73, 4
    buffer_load_dwordx4 v16, s[20:23], s63 offen lds
    s_add_u32 m0, s96, 90112
    s_lshl_b32 s63, s74, 4
    buffer_load_dwordx4 v16, s[20:23], s63 offen lds
.Lj10:
    s_load_dwordx2 s[28:29], s[0:1], 64
    s_load_dwordx2 s[8:9], s[0:1], 72
    v_and_b32 v20, 7, v1
    v_lshrrev_b32 v24, 3, v1
    s_lshl_b32 s62, s96, 3
    v_lshlrev_b32 v27, 1, v20
    v_lshlrev_b32 v20, 4, v20
    v_lshl_add_u32 v17, v24, 10, v20
    s_add_u32 s57, s57, s62
    v_xor_b32 v26, v27, v24
    v_xor_b32 v27, 1, v26
    v_lshl_add_u32 v24, v24, 8, s97
    v_add_u32 v24, 98304, v24
    v_lshl_add_u32 v26, v26, 4, v24
    v_lshl_add_u32 v27, v27, 4, v24
    v_and_b32 v24, 7, v2
    v_xor_b32 v24, v24, v3
    v_lshl_add_u32 v21, v2, 8, s62
    v_add_u32 v21, 98304, v21
    v_xor_b32 v12, 0, v24
    v_lshl_add_u32 v12, v12, 4, v21
    v_xor_b32 v13, 2, v24
    v_lshl_add_u32 v13, v13, 4, v21
    v_xor_b32 v14, 4, v24
    v_lshl_add_u32 v14, v14, 4, v21
    v_xor_b32 v15, 6, v24
    v_lshl_add_u32 v15, v15, 4, v21
    s_mov_b32 s30, 1024
    s_mov_b32 s10, 2097152
    s_waitcnt lgkmcnt(0)
    v_mov_b32 v22, 28676
    v_mov_b32 v23, 1
    s_waitcnt vmcnt(0)
    s_mov_b64 exec, 1
    ds_add_rtn_u32 v22, v22, v23
    s_mov_b64 exec, -1
    s_waitcnt lgkmcnt(0)
    v_readfirstlane_b32 s48, v22
    s_nop 0
    s_cmp_lg_u32 s48, 7
    s_cbranch_scc1 .Lkf13
    v_mov_b32 v40, s100
    v_mov_b32 v41, s101
    buffer_store_dwordx2 v[40:41], v25, s[12:15], s54 offen sc1
.Lkf13:
    s_waitcnt vmcnt(0)
    s_barrier
    ds_read_b64_tr_b16 v[128:129], v4 offset:0
    ds_read_b64_tr_b16 v[130:131], v4 offset:1024
    ds_read_b64_tr_b16 v[132:133], v5 offset:0
    ds_read_b64_tr_b16 v[134:135], v5 offset:1024
    ds_read_b64_tr_b16 v[136:137], v4 offset:8192
    ds_read_b64_tr_b16 v[138:139], v4 offset:9216
    ds_read_b64_tr_b16 v[140:141], v5 offset:8192
    ds_read_b64_tr_b16 v[142:143], v5 offset:9216
    ds_read_b64_tr_b16 v[144:145], v4 offset:16384
    ds_read_b64_tr_b16 v[146:147], v4 offset:17408
    ds_read_b64_tr_b16 v[148:149], v5 offset:16384
    ds_read_b64_tr_b16 v[150:151], v5 offset:17408
    ds_read_b64_tr_b16 v[152:153], v4 offset:32768
    ds_read_b64_tr_b16 v[154:155], v4 offset:33792
    ds_read_b64_tr_b16 v[156:157], v5 offset:32768
    ds_read_b64_tr_b16 v[158:159], v5 offset:33792
    ds_read_b64_tr_b16 v[160:161], v4 offset:40960
    ds_read_b64_tr_b16 v[162:163], v4 offset:41984
    ds_read_b64_tr_b16 v[164:165], v5 offset:40960
    ds_read_b64_tr_b16 v[166:167], v5 offset:41984
    ds_read_b64_tr_b16 v[168:169], v4 offset:49152
    ds_read_b64_tr_b16 v[170:171], v4 offset:50176
    ds_read_b64_tr_b16 v[172:173], v5 offset:49152
    ds_read_b64_tr_b16 v[174:175], v5 offset:50176
    ds_read_b64_tr_b16 v[176:177], v4 offset:57344
    ds_read_b64_tr_b16 v[178:179], v4 offset:58368
    ds_read_b64_tr_b16 v[180:181], v5 offset:57344
    ds_read_b64_tr_b16 v[182:183], v5 offset:58368
    ds_read_b64_tr_b16 v[184:185], v6 offset:0
    ds_read_b64_tr_b16 v[186:187], v6 offset:1024
    ds_read_b64_tr_b16 v[188:189], v7 offset:0
    ds_read_b64_tr_b16 v[190:191], v7 offset:1024
    ds_read_b64_tr_b16 v[192:193], v6 offset:8192
    ds_read_b64_tr_b16 v[194:195], v6 offset:9216
    ds_read_b64_tr_b16 v[196:197], v7 offset:8192
    ds_read_b64_tr_b16 v[198:199], v7 offset:9216
    ds_read_b64_tr_b16 v[200:201], v6 offset:16384
    ds_read_b64_tr_b16 v[202:203], v6 offset:17408
    ds_read_b64_tr_b16 v[204:205], v7 offset:16384
    ds_read_b64_tr_b16 v[206:207], v7 offset:17408
    ds_read_b64_tr_b16 v[208:209], v6 offset:24576
    ds_read_b64_tr_b16 v[210:211], v6 offset:25600
    ds_read_b64_tr_b16 v[212:213], v7 offset:24576
    ds_read_b64_tr_b16 v[214:215], v7 offset:25600
    s_add_u32 m0, s96, 98304
    s_lshl_b32 s63, s75, 4
    buffer_load_dwordx4 v16, s[20:23], s63 offen lds
    s_add_u32 m0, s96, 106496
    s_lshl_b32 s63, s76, 4
    buffer_load_dwordx4 v16, s[20:23], s63 offen lds
    s_add_u32 m0, s96, 114688
    s_lshl_b32 s63, s77, 4
    buffer_load_dwordx4 v16, s[20:23], s63 offen lds
    s_add_u32 m0, s96, 122880
    s_lshl_b32 s63, s78, 4
    buffer_load_dwordx4 v16, s[20:23], s63 offen lds
    s_add_u32 m0, s96, 131072
    s_lshl_b32 s63, s79, 4
    buffer_load_dwordx4 v16, s[20:23], s63 offen lds
    s_add_u32 m0, s96, 139264
    s_lshl_b32 s63, s80, 4
    buffer_load_dwordx4 v16, s[20:23], s63 offen lds
    s_add_u32 m0, s96, 147456
    s_lshl_b32 s63, s81, 4
    buffer_load_dwordx4 v16, s[20:23], s63 offen lds
    s_add_u32 m0, s96, 155648
    s_lshl_b32 s63, s82, 4
    buffer_load_dwordx4 v16, s[20:23], s63 offen lds
    s_waitcnt lgkmcnt(0)
    s_barrier
    v_mov_b32 v28, 0
    v_mov_b32 v29, 0
    ds_write_b64 v28, v[28:29] offset:0
    ds_write_b32 v28, v28 offset:8
    s_add_u32 m0, s96, 8192
    s_lshl_b32 s63, s83, 4
    buffer_load_dwordx4 v16, s[20:23], s63 offen lds
    s_add_u32 m0, s96, 16384
    s_lshl_b32 s63, s84, 4
    buffer_load_dwordx4 v16, s[20:23], s63 offen lds
    s_add_u32 m0, s96, 24576
    s_lshl_b32 s63, s85, 4
    buffer_load_dwordx4 v16, s[20:23], s63 offen lds
    s_add_u32 m0, s96, 32768
    s_lshl_b32 s63, s86, 4
    buffer_load_dwordx4 v16, s[24:27], s63 offen lds
    s_add_u32 m0, s96, 40960
    s_lshl_b32 s63, s87, 4
    buffer_load_dwordx4 v16, s[24:27], s63 offen lds
    s_add_u32 m0, s96, 49152
    s_lshl_b32 s63, s88, 4
    buffer_load_dwordx4 v16, s[24:27], s63 offen lds
    s_add_u32 m0, s96, 57344
    s_lshl_b32 s63, s89, 4
    buffer_load_dwordx4 v16, s[24:27], s63 offen lds
    s_add_u32 m0, s96, 65536
    s_lshl_b32 s63, s90, 4
    buffer_load_dwordx4 v16, s[24:27], s63 offen lds
    s_add_u32 m0, s96, 73728
    s_lshl_b32 s63, s91, 4
    buffer_load_dwordx4 v16, s[24:27], s63 offen lds
    s_add_u32 m0, s96, 81920
    s_lshl_b32 s63, s92, 4
    buffer_load_dwordx4 v16, s[24:27], s63 offen lds
    s_add_u32 m0, s96, 90112
    s_lshl_b32 s63, s93, 4
    buffer_load_dwordx4 v16, s[24:27], s63 offen lds
    v_mov_b32 v112, 0
    s_waitcnt lgkmcnt(0)
    s_cmp_lg_u32 s96, 0
    s_cbranch_scc1 .Lpd14
    v_and_b32 v118, 15, v1
    v_lshlrev_b32 v118, 3, v118
    s_mov_b32 s3, 0
.Lpl15:
    buffer_load_dwordx2 v[116:117], v118, s[12:15], s59 offen sc1
    s_add_u32 s3, s3, 1
    s_waitcnt vmcnt(0)
    v_cmp_eq_u64 vcc, s[100:101], v[116:117]
    s_nop 0
    s_cmp_eq_u64 vcc, exec
    s_cbranch_scc1 .Lpd14
    s_cmp_lt_u32 s3, 20000
    s_cbranch_scc1 .Lpl15
.Lpd14:
    s_barrier
    s_add_u32 s48, s64, s58
    buffer_load_dwordx4 v[216:219], v30, s[12:15], s48 offen sc1
    s_add_u32 s48, s65, s58
    buffer_load_dwordx4 v[220:223], v30, s[12:15], s48 offen sc1
    s_add_u32 s48, s66, s58
    buffer_load_dwordx4 v[224:227], v30, s[12:15], s48 offen sc1
    s_add_u32 s48, s67, s58
    buffer_load_dwordx4 v[228:231], v30, s[12:15], s48 offen sc1
    s_add_u32 s48, s68, s58
    buffer_load_dwordx4 v[232:235], v30, s[12:15], s48 offen sc1
    s_waitcnt vmcnt(4)
    v_mfma_f32_32x32x16_bf16 v[32:47], v[128:131], v[216:219], 0
    v_mfma_f32_32x32x16_bf16 v[48:63], v[132:135], v[216:219], 0
    s_add_u32 s48, s69, s58
    buffer_load_dwordx4 v[236:239], v30, s[12:15], s48 offen sc1
    s_waitcnt vmcnt(4)
    v_mfma_f32_32x32x16_bf16 v[32:47], v[136:139], v[220:223], v[32:47]
    v_mfma_f32_32x32x16_bf16 v[48:63], v[140:143], v[220:223], v[48:63]
    s_add_u32 s48, s70, s58
    buffer_load_dwordx4 v[240:243], v30, s[12:15], s48 offen sc1
    s_waitcnt vmcnt(4)
    v_mfma_f32_32x32x16_bf16 v[32:47], v[144:147], v[224:227], v[32:47]
    v_mfma_f32_32x32x16_bf16 v[48:63], v[148:151], v[224:227], v[48:63]
    s_add_u32 s48, s71, s58
    buffer_load_dwordx4 v[244:247], v30, s[12:15], s48 offen sc1
    s_waitcnt vmcnt(4)
    v_mfma_f32_32x32x16_bf16 v[32:47], v[152:155], v[228:231], v[32:47]
    v_mfma_f32_32x32x16_bf16 v[48:63], v[156:159], v[228:231], v[48:63]
    s_add_u32 s48, s72, s58
    buffer_load_dwordx4 v[248:251], v30, s[12:15], s48 offen sc1
    s_waitcnt vmcnt(4)
    v_mfma_f32_32x32x16_bf16 v[32:47], v[160:163], v[232:235], v[32:47]
    v_mfma_f32_32x32x16_bf16 v[48:63], v[164:167], v[232:235], v[48:63]
    s_add_u32 s48, s73, s58
    buffer_load_dwordx4 v[252:255], v30, s[12:15], s48 offen sc1
    s_waitcnt vmcnt(4)
    v_mfma_f32_32x32x16_bf16 v[32:47], v[168:171], v[236:239], v[32:47]
    v_mfma_f32_32x32x16_bf16 v[48:63], v[172:175], v[236:239], v[48:63]
    s_add_u32 s48, s74, s58
    buffer_load_dwordx4 v[216:219], v30, s[12:15], s48 offen sc1
    s_waitcnt vmcnt(4)
    v_mfma_f32_32x32x16_bf16 v[32:47], v[176:179], v[240:243], v[32:47]
    v_mfma_f32_32x32x16_bf16 v[48:63], v[180:183], v[240:243], v[48:63]
    s_add_u32 s48, s75, s58
    buffer_load_dwordx4 v[220:223], v30, s[12:15], s48 offen sc1
    s_waitcnt vmcnt(4)
    v_mfma_f32_32x32x16_bf16 v[32:47], v[184:187], v[244:247], v[32:47]
    v_mfma_f32_32x32x16_bf16 v[48:63], v[188:191], v[244:247], v[48:63]
    s_add_u32 s48, s76, s58
    buffer_load_dwordx4 v[224:227], v30, s[12:15], s48 offen sc1
    s_waitcnt vmcnt(4)
    v_mfma_f32_32x32x16_bf16 v[32:47], v[192:195], v[248:251], v[32:47]
    v_mfma_f32_32x32x16_bf16 v[48:63], v[196:199], v[248:251], v[48:63]
    s_barrier
    ds_read_b64_tr_b16 v[88:89], v6 offset:32768
    ds_read_b64_tr_b16 v[90:91], v6 offset:33792
    ds_read_b64_tr_b16 v[92:93], v7 offset:32768
    ds_read_b64_tr_b16 v[94:95], v7 offset:33792
    ds_read_b64_tr_b16 v[64:65], v6 offset:40960
    ds_read_b64_tr_b16 v[66:67], v6 offset:41984
    ds_read_b64_tr_b16 v[68:69], v7 offset:40960
    ds_read_b64_tr_b16 v[70:71], v7 offset:41984
    ds_read_b64_tr_b16 v[72:73], v6 offset:49152
    ds_read_b64_tr_b16 v[74:75], v6 offset:50176
    ds_read_b64_tr_b16 v[76:77], v7 offset:49152
    ds_read_b64_tr_b16 v[78:79], v7 offset:50176
    s_add_u32 s48, s77, s58
    buffer_load_dwordx4 v[228:231], v30, s[12:15], s48 offen sc1
    s_waitcnt vmcnt(4)
    v_mfma_f32_32x32x16_bf16 v[32:47], v[200:203], v[252:255], v[32:47]
    v_mfma_f32_32x32x16_bf16 v[48:63], v[204:207], v[252:255], v[48:63]
    s_add_u32 s48, s78, s58
    buffer_load_dwordx4 v[232:235], v30, s[12:15], s48 offen sc1
    s_waitcnt vmcnt(4)
    v_mfma_f32_32x32x16_bf16 v[32:47], v[208:211], v[216:219], v[32:47]
    v_mfma_f32_32x32x16_bf16 v[48:63], v[212:215], v[216:219], v[48:63]
    s_add_u32 s48, s79, s58
    buffer_load_dwordx4 v[236:239], v30, s[12:15], s48 offen sc1
    v_and_b32 v118, 7, v1
    s_cmp_eq_u32 s96, 0
    v_lshlrev_b32 v118, 3, v118
    s_cselect_b32 s48, s59, 0x20000000
    v_add_u32 v118, 4096, v118
    buffer_load_dwordx2 v[116:117], v118, s[12:15], s48 offen sc1
    s_waitcnt vmcnt(5)
    s_waitcnt lgkmcnt(8)
    v_mfma_f32_32x32x16_bf16 v[32:47], v[88:91], v[220:223], v[32:47]
    v_mfma_f32_32x32x16_bf16 v[48:63], v[92:95], v[220:223], v[48:63]
    ds_read_b64_tr_b16 v[80:81], v6 offset:57344
    ds_read_b64_tr_b16 v[82:83], v6 offset:58368
    ds_read_b64_tr_b16 v[84:85], v7 offset:57344
    ds_read_b64_tr_b16 v[86:87], v7 offset:58368
    s_add_u32 s48, s80, s58
    buffer_load_dwordx4 v[240:243], v30, s[12:15], s48 offen sc1
    s_waitcnt vmcnt(5)
    s_waitcnt lgkmcnt(8)
    v_mfma_f32_32x32x16_bf16 v[32:47], v[64:67], v[224:227], v[32:47]
    v_mfma_f32_32x32x16_bf16 v[48:63], v[68:71], v[224:227], v[48:63]
    ds_read_b64_tr_b16 v[88:89], v10 offset:0
    ds_read_b64_tr_b16 v[90:91], v10 offset:1024
    ds_read_b64_tr_b16 v[92:93], v11 offset:0
    ds_read_b64_tr_b16 v[94:95], v11 offset:1024
    s_add_u32 s48, s81, s58
    buffer_load_dwordx4 v[244:247], v30, s[12:15], s48 offen sc1
    s_waitcnt vmcnt(5)
    s_waitcnt lgkmcnt(8)
    v_mfma_f32_32x32x16_bf16 v[32:47], v[72:75], v[228:231], v[32:47]
    v_mfma_f32_32x32x16_bf16 v[48:63], v[76:79], v[228:231], v[48:63]
    ds_read_b64_tr_b16 v[64:65], v10 offset:8192
    ds_read_b64_tr_b16 v[66:67], v10 offset:9216
    ds_read_b64_tr_b16 v[68:69], v11 offset:8192
    ds_read_b64_tr_b16 v[70:71], v11 offset:9216
    s_add_u32 s48, s82, s58
    buffer_load_dwordx4 v[248:251], v30, s[12:15], s48 offen sc1
    s_waitcnt vmcnt(5)
    s_waitcnt lgkmcnt(8)
    v_mfma_f32_32x32x16_bf16 v[32:47], v[80:83], v[232:235], v[32:47]
    v_mfma_f32_32x32x16_bf16 v[48:63], v[84:87], v[232:235], v[48:63]
    ds_read_b64_tr_b16 v[72:73], v10 offset:16384
    ds_read_b64_tr_b16 v[74:75], v10 offset:17408
    ds_read_b64_tr_b16 v[76:77], v11 offset:16384
    ds_read_b64_tr_b16 v[78:79], v11 offset:17408
    s_add_u32 s48, s83, s58
    buffer_load_dwordx4 v[252:255], v30, s[12:15], s48 offen sc1
    s_waitcnt vmcnt(4)
    v_cmp_eq_u64 vcc, s[100:101], v[116:117]
    s_nop 0
    s_cmp_eq_u64 vcc, exec
    s_cbranch_scc0 .Leo16
    ds_write_b64 v112, v[116:117]
.Leo16:
    s_waitcnt lgkmcnt(8)
    v_mfma_f32_32x32x16_bf16 v[32:47], v[88:91], v[236:239], v[32:47]
    v_mfma_f32_32x32x16_bf16 v[48:63], v[92:95], v[236:239], v[48:63]
    ds_read_b64_tr_b16 v[80:81], v10 offset:24576
    ds_read_b64_tr_b16 v[82:83], v10 offset:25600
    ds_read_b64_tr_b16 v[84:85], v11 offset:24576
    ds_read_b64_tr_b16 v[86:87], v11 offset:25600
    s_add_u32 s48, s84, s58
    buffer_load_dwordx4 v[216:219], v30, s[12:15], s48 offen sc1
    s_waitcnt vmcnt(4)
    s_waitcnt lgkmcnt(8)
    v_mfma_f32_32x32x16_bf16 v[32:47], v[64:67], v[240:243], v[32:47]
    v_mfma_f32_32x32x16_bf16 v[48:63], v[68:71], v[240:243], v[48:63]
    ds_read_b64_tr_b16 v[88:89], v4 offset:8192
    ds_read_b64_tr_b16 v[90:91], v4 offset:9216
    ds_read_b64_tr_b16 v[92:93], v5 offset:8192
    ds_read_b64_tr_b16 v[94:95], v5 offset:9216
    s_add_u32 s48, s85, s58
    buffer_load_dwordx4 v[220:223], v30, s[12:15], s48 offen sc1
    ds_read_b64 v[114:115], v112
    s_waitcnt vmcnt(4)
    s_waitcnt lgkmcnt(9)
    v_mfma_f32_32x32x16_bf16 v[32:47], v[72:75], v[244:247], v[32:47]
    v_mfma_f32_32x32x16_bf16 v[48:63], v[76:79], v[244:247], v[48:63]
    ds_read_b64_tr_b16 v[64:65], v4 offset:16384
    ds_read_b64_tr_b16 v[66:67], v4 offset:17408
    ds_read_b64_tr_b16 v[68:69], v5 offset:16384
    ds_read_b64_tr_b16 v[70:71], v5 offset:17408
    buffer_load_dwordx4 v[120:123], v17, s[4:7], s57 offen
    buffer_load_dwordx4 v[124:127], v20, s[28:31], s61 offen
    s_waitcnt lgkmcnt(4)
    v_cmp_eq_u64 vcc, s[100:101], v[114:115]
    s_nop 0
    s_cmp_eq_u64 vcc, exec
    s_cbranch_scc0 .Llate17
    s_add_u32 s48, s86, s58
    buffer_load_dwordx4 v[128:131], v30, s[12:15], s48 offen sc1
    s_add_u32 s48, s87, s58
    buffer_load_dwordx4 v[132:135], v30, s[12:15], s48 offen sc1
    s_add_u32 s48, s88, s58
    buffer_load_dwordx4 v[136:139], v30, s[12:15], s48 offen sc1
    s_add_u32 s48, s89, s58
    buffer_load_dwordx4 v[140:143], v30, s[12:15], s48 offen sc1
    s_add_u32 s48, s90, s58
    buffer_load_dwordx4 v[144:147], v30, s[12:15], s48 offen sc1
    s_add_u32 s48, s91, s58
    buffer_load_dwordx4 v[148:151], v30, s[12:15], s48 offen sc1
    s_add_u32 s48, s92, s58
    buffer_load_dwordx4 v[152:155], v30, s[12:15], s48 offen sc1
    s_add_u32 s48, s93, s58
    buffer_load_dwordx4 v[156:159], v30, s[12:15], s48 offen sc1
    s_waitcnt vmcnt(13)
    v_mfma_f32_32x32x16_bf16 v[32:47], v[80:83], v[248:251], v[32:47]
    v_mfma_f32_32x32x16_bf16 v[48:63], v[84:87], v[248:251], v[48:63]
    ds_read_b64_tr_b16 v[72:73], v4 offset:24576
    ds_read_b64_tr_b16 v[74:75], v4 offset:25600
    ds_read_b64_tr_b16 v[76:77], v5 offset:24576
    ds_read_b64_tr_b16 v[78:79], v5 offset:25600
    s_waitcnt vmcnt(12)
    v_mfma_f32_32x32x16_bf16 v[32:47], v[88:91], v[252:255], v[32:47]
    v_mfma_f32_32x32x16_bf16 v[48:63], v[92:95], v[252:255], v[48:63]
    ds_read_b64_tr_b16 v[80:81], v4 offset:32768
    ds_read_b64_tr_b16 v[82:83], v4 offset:33792
    ds_read_b64_tr_b16 v[84:85], v5 offset:32768
    ds_read_b64_tr_b16 v[86:87], v5 offset:33792
    s_barrier
    s_waitcnt vmcnt(11)
    s_waitcnt lgkmcnt(8)
    v_mfma_f32_32x32x16_bf16 v[32:47], v[64:67], v[216:219], v[32:47]
    v_mfma_f32_32x32x16_bf16 v[48:63], v[68:71], v[216:219], v[48:63]
    ds_read_b64_tr_b16 v[88:89], v4 offset:40960
    ds_read_b64_tr_b16 v[90:91], v4 offset:41984
    ds_read_b64_tr_b16 v[92:93], v5 offset:40960
    ds_read_b64_tr_b16 v[94:95], v5 offset:41984
    s_waitcnt vmcnt(10)
    s_waitcnt lgkmcnt(8)
    v_mfma_f32_32x32x16_bf16 v[32:47], v[72:75], v[220:223], v[32:47]
    v_mfma_f32_32x32x16_bf16 v[48:63], v[76:79], v[220:223], v[48:63]
    ds_read_b64_tr_b16 v[64:65], v4 offset:49152
    ds_read_b64_tr_b16 v[66:67], v4 offset:50176
    ds_read_b64_tr_b16 v[68:69], v5 offset:49152
    ds_read_b64_tr_b16 v[70:71], v5 offset:50176
    s_waitcnt vmcnt(7)
    s_waitcnt lgkmcnt(8)
    v_mfma_f32_32x32x16_bf16 v[32:47], v[80:83], v[128:131], v[32:47]
    v_mfma_f32_32x32x16_bf16 v[48:63], v[84:87], v[128:131], v[48:63]
    ds_read_b64_tr_b16 v[72:73], v4 offset:57344
    ds_read_b64_tr_b16 v[74:75], v4 offset:58368
    ds_read_b64_tr_b16 v[76:77], v5 offset:57344
    ds_read_b64_tr_b16 v[78:79], v5 offset:58368
    s_waitcnt vmcnt(6)
    s_waitcnt lgkmcnt(8)
    v_mfma_f32_32x32x16_bf16 v[32:47], v[88:91], v[132:135], v[32:47]
    v_mfma_f32_32x32x16_bf16 v[48:63], v[92:95], v[132:135], v[48:63]
    ds_read_b64_tr_b16 v[80:81], v6 offset:0
    ds_read_b64_tr_b16 v[82:83], v6 offset:1024
    ds_read_b64_tr_b16 v[84:85], v7 offset:0
    ds_read_b64_tr_b16 v[86:87], v7 offset:1024
    s_waitcnt vmcnt(5)
    s_waitcnt lgkmcnt(8)
    v_mfma_f32_32x32x16_bf16 v[32:47], v[64:67], v[136:139], v[32:47]
    v_mfma_f32_32x32x16_bf16 v[48:63], v[68:71], v[136:139], v[48:63]
    ds_read_b64_tr_b16 v[88:89], v6 offset:8192
    ds_read_b64_tr_b16 v[90:91], v6 offset:9216
    ds_read_b64_tr_b16 v[92:93], v7 offset:8192
    ds_read_b64_tr_b16 v[94:95], v7 offset:9216
    s_waitcnt vmcnt(4)
    s_waitcnt lgkmcnt(8)
    v_mfma_f32_32x32x16_bf16 v[32:47], v[72:75], v[140:143], v[32:47]
    v_mfma_f32_32x32x16_bf16 v[48:63], v[76:79], v[140:143], v[48:63]
    ds_read_b64_tr_b16 v[64:65], v6 offset:16384
    ds_read_b64_tr_b16 v[66:67], v6 offset:17408
    ds_read_b64_tr_b16 v[68:69], v7 offset:16384
    ds_read_b64_tr_b16 v[70:71], v7 offset:17408
    s_waitcnt vmcnt(3)
    s_waitcnt lgkmcnt(8)
    v_mfma_f32_32x32x16_bf16 v[32:47], v[80:83], v[144:147], v[32:47]
    v_mfma_f32_32x32x16_bf16 v[48:63], v[84:87], v[144:147], v[48:63]
    ds_read_b64_tr_b16 v[72:73], v6 offset:24576
    ds_read_b64_tr_b16 v[74:75], v6 offset:25600
    ds_read_b64_tr_b16 v[76:77], v7 offset:24576
    ds_read_b64_tr_b16 v[78:79], v7 offset:25600
    s_waitcnt vmcnt(2)
    s_waitcnt lgkmcnt(8)
    v_mfma_f32_32x32x16_bf16 v[32:47], v[88:91], v[148:151], v[32:47]
    v_mfma_f32_32x32x16_bf16 v[48:63], v[92:95], v[148:151], v[48:63]
    s_waitcnt vmcnt(1)
    s_waitcnt lgkmcnt(4)
    v_mfma_f32_32x32x16_bf16 v[32:47], v[64:67], v[152:155], v[32:47]
    v_mfma_f32_32x32x16_bf16 v[48:63], v[68:71], v[152:155], v[48:63]
    s_waitcnt vmcnt(0)
    s_waitcnt lgkmcnt(0)
    v_mfma_f32_32x32x16_bf16 v[32:47], v[72:75], v[156:159], v[32:47]
    v_mfma_f32_32x32x16_bf16 v[48:63], v[76:79], v[156:159], v[48:63]
    s_branch .Ljoin18
.Llate17:
    s_waitcnt vmcnt(5)
    v_mfma_f32_32x32x16_bf16 v[32:47], v[80:83], v[248:251], v[32:47]
    v_mfma_f32_32x32x16_bf16 v[48:63], v[84:87], v[248:251], v[48:63]
    ds_read_b64_tr_b16 v[72:73], v4 offset:24576
    ds_read_b64_tr_b16 v[74:75], v4 offset:25600
    ds_read_b64_tr_b16 v[76:77], v5 offset:24576
    ds_read_b64_tr_b16 v[78:79], v5 offset:25600
    s_waitcnt vmcnt(4)
    v_mfma_f32_32x32x16_bf16 v[32:47], v[88:91], v[252:255], v[32:47]
    v_mfma_f32_32x32x16_bf16 v[48:63], v[92:95], v[252:255], v[48:63]
    ds_read_b64_tr_b16 v[80:81], v4 offset:32768
    ds_read_b64_tr_b16 v[82:83], v4 offset:33792
    ds_read_b64_tr_b16 v[84:85], v5 offset:32768
    ds_read_b64_tr_b16 v[86:87], v5 offset:33792
    s_barrier
    s_waitcnt vmcnt(3)
    s_waitcnt lgkmcnt(8)
    v_mfma_f32_32x32x16_bf16 v[32:47], v[64:67], v[216:219], v[32:47]
    v_mfma_f32_32x32x16_bf16 v[48:63], v[68:71], v[216:219], v[48:63]
    ds_read_b64_tr_b16 v[88:89], v4 offset:40960
    ds_read_b64_tr_b16 v[90:91], v4 offset:41984
    ds_read_b64_tr_b16 v[92:93], v5 offset:40960
    ds_read_b64_tr_b16 v[94:95], v5 offset:41984
    s_waitcnt vmcnt(2)
    s_waitcnt lgkmcnt(8)
    v_mfma_f32_32x32x16_bf16 v[32:47], v[72:75], v[220:223], v[32:47]
    v_mfma_f32_32x32x16_bf16 v[48:63], v[76:79], v[220:223], v[48:63]
    ds_read_b64_tr_b16 v[64:65], v4 offset:49152
    ds_read_b64_tr_b16 v[66:67], v4 offset:50176
    ds_read_b64_tr_b16 v[68:69], v5 offset:49152
    ds_read_b64_tr_b16 v[70:71], v5 offset:50176
    s_cmp_lg_u32 s96, 0
    s_mov_b32 s3, 0
    s_cbranch_scc1 .Lw20
    v_and_b32 v118, 7, v1
    v_lshlrev_b32 v118, 3, v118
    s_mov_b32 s3, 0
    v_add_u32 v118, 4096, v118
.Lpl22:
    buffer_load_dwordx2 v[116:117], v118, s[12:15], s59 offen sc1
    s_add_u32 s3, s3, 1
    s_waitcnt vmcnt(0)
    v_cmp_eq_u64 vcc, s[100:101], v[116:117]
    s_nop 0
    s_cmp_eq_u64 vcc, exec
    s_cbranch_scc1 .Lset21
    s_cmp_lt_u32 s3, 20000
    s_cbranch_scc1 .Lpl22
.Lset21:
    v_mov_b32 v116, s100
    v_mov_b32 v117, s101
    ds_write_b64 v112, v[116:117]
    s_branch .Lgo19
.Lw20:
    ds_read_b64 v[114:115], v112
    s_add_u32 s3, s3, 1
    s_waitcnt lgkmcnt(0)
    v_cmp_eq_u64 vcc, s[100:101], v[114:115]
    s_nop 0
    s_cmp_eq_u64 vcc, exec
    s_cbranch_scc1 .Lgo19
    s_sleep 1
    s_cmp_lt_u32 s3, 400000
    s_cbranch_scc1 .Lw20
.Lgo19:
    s_add_u32 s48, s86, s58
    buffer_load_dwordx4 v[128:131], v30, s[12:15], s48 offen sc1
    s_add_u32 s48, s87, s58
    buffer_load_dwordx4 v[132:135], v30, s[12:15], s48 offen sc1
    s_add_u32 s48, s88, s58
    buffer_load_dwordx4 v[136:139], v30, s[12:15], s48 offen sc1
    s_add_u32 s48, s89, s58
    buffer_load_dwordx4 v[140:143], v30, s[12:15], s48 offen sc1
    s_add_u32 s48, s90, s58
    buffer_load_dwordx4 v[144:147], v30, s[12:15], s48 offen sc1
    s_add_u32 s48, s91, s58
    buffer_load_dwordx4 v[148:151], v30, s[12:15], s48 offen sc1
    s_add_u32 s48, s92, s58
    buffer_load_dwordx4 v[152:155], v30, s[12:15], s48 offen sc1
    s_add_u32 s48, s93, s58
    buffer_load_dwordx4 v[156:159], v30, s[12:15], s48 offen sc1
    s_waitcnt vmcnt(7)
    s_waitcnt lgkmcnt(8)
    v_mfma_f32_32x32x16_bf16 v[32:47], v[80:83], v[128:131], v[32:47]
    v_mfma_f32_32x32x16_bf16 v[48:63], v[84:87], v[128:131], v[48:63]
    ds_read_b64_tr_b16 v[72:73], v4 offset:57344
    ds_read_b64_tr_b16 v[74:75], v4 offset:58368
    ds_read_b64_tr_b16 v[76:77], v5 offset:57344
    ds_read_b64_tr_b16 v[78:79], v5 offset:58368
    s_waitcnt vmcnt(6)
    s_waitcnt lgkmcnt(8)
    v_mfma_f32_32x32x16_bf16 v[32:47], v[88:91], v[132:135], v[32:47]
    v_mfma_f32_32x32x16_bf16 v[48:63], v[92:95], v[132:135], v[48:63]
    ds_read_b64_tr_b16 v[80:81], v6 offset:0
    ds_read_b64_tr_b16 v[82:83], v6 offset:1024
    ds_read_b64_tr_b16 v[84:85], v7 offset:0
    ds_read_b64_tr_b16 v[86:87], v7 offset:1024
    s_waitcnt vmcnt(5)
    s_waitcnt lgkmcnt(8)
    v_mfma_f32_32x32x16_bf16 v[32:47], v[64:67], v[136:139], v[32:47]
    v_mfma_f32_32x32x16_bf16 v[48:63], v[68:71], v[136:139], v[48:63]
    ds_read_b64_tr_b16 v[88:89], v6 offset:8192
    ds_read_b64_tr_b16 v[90:91], v6 offset:9216
    ds_read_b64_tr_b16 v[92:93], v7 offset:8192
    ds_read_b64_tr_b16 v[94:95], v7 offset:9216
    s_waitcnt vmcnt(4)
    s_waitcnt lgkmcnt(8)
    v_mfma_f32_32x32x16_bf16 v[32:47], v[72:75], v[140:143], v[32:47]
    v_mfma_f32_32x32x16_bf16 v[48:63], v[76:79], v[140:143], v[48:63]
    ds_read_b64_tr_b16 v[64:65], v6 offset:16384
    ds_read_b64_tr_b16 v[66:67], v6 offset:17408
    ds_read_b64_tr_b16 v[68:69], v7 offset:16384
    ds_read_b64_tr_b16 v[70:71], v7 offset:17408
    s_waitcnt vmcnt(3)
    s_waitcnt lgkmcnt(8)
    v_mfma_f32_32x32x16_bf16 v[32:47], v[80:83], v[144:147], v[32:47]
    v_mfma_f32_32x32x16_bf16 v[48:63], v[84:87], v[144:147], v[48:63]
    ds_read_b64_tr_b16 v[72:73], v6 offset:24576
    ds_read_b64_tr_b16 v[74:75], v6 offset:25600
    ds_read_b64_tr_b16 v[76:77], v7 offset:24576
    ds_read_b64_tr_b16 v[78:79], v7 offset:25600
    s_waitcnt vmcnt(2)
    s_waitcnt lgkmcnt(8)
    v_mfma_f32_32x32x16_bf16 v[32:47], v[88:91], v[148:151], v[32:47]
    v_mfma_f32_32x32x16_bf16 v[48:63], v[92:95], v[148:151], v[48:63]
    s_waitcnt vmcnt(1)
    s_waitcnt lgkmcnt(4)
    v_mfma_f32_32x32x16_bf16 v[32:47], v[64:67], v[152:155], v[32:47]
    v_mfma_f32_32x32x16_bf16 v[48:63], v[68:71], v[152:155], v[48:63]
    s_waitcnt vmcnt(0)
    s_waitcnt lgkmcnt(0)
    v_mfma_f32_32x32x16_bf16 v[32:47], v[72:75], v[156:159], v[32:47]
    v_mfma_f32_32x32x16_bf16 v[48:63], v[76:79], v[156:159], v[48:63]
.Ljoin18:
    s_nop 3
    v_lshlrev_b32 v64, 16, v120
    v_and_b32 v65, 0xffff0000, v120
    v_lshlrev_b32 v66, 16, v121
    v_and_b32 v67, 0xffff0000, v121
    v_lshlrev_b32 v68, 16, v122
    v_and_b32 v69, 0xffff0000, v122
    v_lshlrev_b32 v70, 16, v123
    v_and_b32 v71, 0xffff0000, v123
    s_nop 1
    ds_write_b128 v12, v[32:35] offset:0
    ds_write_b128 v13, v[36:39] offset:0
    ds_write_b128 v14, v[40:43] offset:0
    ds_write_b128 v15, v[44:47] offset:0
    ds_write_b128 v12, v[48:51] offset:128
    ds_write_b128 v13, v[52:55] offset:128
    ds_write_b128 v14, v[56:59] offset:128
    ds_write_b128 v15, v[60:63] offset:128
    v_lshlrev_b32 v72, 16, v124
    v_and_b32 v73, 0xffff0000, v124
    v_lshlrev_b32 v74, 16, v125
    v_and_b32 v75, 0xffff0000, v125
    v_lshlrev_b32 v76, 16, v126
    v_and_b32 v77, 0xffff0000, v126
    v_lshlrev_b32 v78, 16, v127
    v_and_b32 v79, 0xffff0000, v127
    v_add_f32 v64, v64, v72
    v_add_f32 v65, v65, v73
    v_add_f32 v66, v66, v74
    v_add_f32 v67, v67, v75
    v_add_f32 v68, v68, v76
    v_add_f32 v69, v69, v77
    v_add_f32 v70, v70, v78
    v_add_f32 v71, v71, v79
    s_waitcnt lgkmcnt(0)
    s_barrier
    ds_read_b128 v[128:131], v26 offset:0
    ds_read_b128 v[132:135], v27 offset:0
    ds_read_b128 v[136:139], v26 offset:16384
    ds_read_b128 v[140:143], v27 offset:16384
    ds_read_b128 v[144:147], v26 offset:32768
    ds_read_b128 v[148:151], v27 offset:32768
    ds_read_b128 v[152:155], v26 offset:49152
    ds_read_b128 v[156:159], v27 offset:49152
    s_waitcnt lgkmcnt(6)
    v_add_f32 v64, v64, v128
    v_add_f32 v65, v65, v129
    v_add_f32 v66, v66, v130
    v_add_f32 v67, v67, v131
    v_add_f32 v68, v68, v132
    v_add_f32 v69, v69, v133
    v_add_f32 v70, v70, v134
    v_add_f32 v71, v71, v135
    s_waitcnt lgkmcnt(4)
    v_add_f32 v64, v64, v136
    v_add_f32 v65, v65, v137
    v_add_f32 v66, v66, v138
    v_add_f32 v67, v67, v139
    v_add_f32 v68, v68, v140
    v_add_f32 v69, v69, v141
    v_add_f32 v70, v70, v142
    v_add_f32 v71, v71, v143
    s_waitcnt lgkmcnt(2)
    v_add_f32 v64, v64, v144
    v_add_f32 v65, v65, v145
    v_add_f32 v66, v66, v146
    v_add_f32 v67, v67, v147
    v_add_f32 v68, v68, v148
    v_add_f32 v69, v69, v149
    v_add_f32 v70, v70, v150
    v_add_f32 v71, v71, v151
    s_waitcnt lgkmcnt(0)
    v_add_f32 v64, v64, v152
    v_add_f32 v65, v65, v153
    v_add_f32 v66, v66, v154
    v_add_f32 v67, v67, v155
    v_add_f32 v68, v68, v156
    v_add_f32 v69, v69, v157
    v_add_f32 v70, v70, v158
    v_add_f32 v71, v71, v159
    v_cvt_pk_bf16_f32 v72, v64, v65
    v_cvt_pk_bf16_f32 v73, v66, v67
    v_cvt_pk_bf16_f32 v74, v68, v69
    v_cvt_pk_bf16_f32 v75, v70, v71
    buffer_store_dwordx4 v[72:75], v17, s[8:11], s57 offen sc1
    s_endpgm
.Lqpath:
    s_load_dwordx2 s[4:5], s[0:1], 0
    s_load_dwordx2 s[8:9], s[0:1], 8
    s_load_dwordx2 s[28:29], s[0:1], 40
    s_load_dwordx2 s[12:13], s[0:1], 88
    s_load_dwordx2 s[16:17], s[0:1], 80
    s_load_dwordx2 s[20:21], s[0:1], 56
    s_load_dwordx2 s[24:25], s[0:1], 24
    s_load_dwordx2 s[80:81], s[0:1], 16
    s_load_dwordx2 s[84:85], s[0:1], 48
    v_lshrrev_b32 v3, 6, v0
    v_and_b32 v1, 63, v0
    v_readfirstlane_b32 s98, v3
    s_bfe_u32 s33, s2, 0x30003
    s_bfe_u32 s34, s2, 0x10002
    s_lshl_b32 s34, s34, 3
    s_add_u32 s33, s33, s34
    s_lshr_b32 s34, s2, 6
    s_lshl_b32 s35, s34, 1
    s_add_u32 s35, s35, s33
    s_and_b32 s35, s35, 7
    s_and_b32 s34, s34, 1
    s_lshl_b32 s34, s34, 2
    s_and_b32 s99, s2, 3
    s_add_u32 s99, s99, s34
    v_lshrrev_b32 v112, 3, v1
    v_lshrrev_b32 v113, 4, v1
    v_and_b32 v114, 7, v1
    s_lshl_b32 s96, s98, 10
    s_lshl_b32 s97, s98, 11
    s_lshl_b32 s34, s98, 14
    v_xor_b32 v16, v114, v113
    v_lshl_add_u32 v17, v112, 10, s34
    v_lshl_add_u32 v16, v16, 4, v17
    v_and_b32 v113, 1, v113
    v_xor_b32 v17, 64, v16
    v_lshlrev_b32 v113, 2, v113
    v_add_u32 v17, 7168, v17
    v_xor_b32 v113, v114, v113
    s_lshl_b32 s34, s98, 3
    v_add_u32 v112, s34, v112
    s_lshl_b32 s34, s99, 7
    s_lshl_b32 s32, s33, 17
    v_lshl_add_u32 v113, v113, 4, s34
    v_mul_u32_u24 v114, 3072, v112
    s_lshl_b32 s33, s35, 7
    s_add_u32 s32, s32, s33
    s_mul_i32 s40, s35, 196608
    v_add3_u32 v18, v114, v113, 0
    v_lshlrev_b32 v30, 4, v1
    s_and_b32 s33, s2, 7
    s_lshl_b32 s33, s33, 18
    s_lshr_b32 s95, s2, 3
    s_lshl_b32 s95, s95, 13
    s_or_b32 s33, s33, s95
    s_add_u32 s33, s33, s96
    s_mov_b32 s6, 2097152
    s_mov_b32 s7, 0x20000
    s_mov_b32 s10, 1572864
    s_mov_b32 s11, 0x20000
    s_mov_b32 s30, 1409024
    s_mov_b32 s31, 0x20000
    v_mul_u32_u24 v20, 2752, v112
    v_add3_u32 v20, v20, v113, s34
    s_mul_i32 s3, s35, 176128
    s_getpc_b64 s[100:101]
    s_add_u32 s100, s100, tblw@rel32@lo+4
    s_addc_u32 s101, s101, tblw@rel32@hi+12
    s_lshl_b32 s37, s99, 11
    s_and_b32 s38, s96, 0x1000
    s_lshr_b32 s38, s38, 2
    s_add_u32 s37, s37, s38
    s_mov_b32 s82, 16384
    s_mov_b32 s83, 0x20000
    s_add_u32 m0, s38, 131072
    s_and_b32 s38, s96, 0xc00
    s_waitcnt lgkmcnt(0)
    s_cbranch_scc1 .Lwp23
    buffer_load_dwordx4 v30, s[80:83], s37 offen lds
.Lwp23:
    buffer_load_dwordx4 v[224:227], v30, s[4:7], s33 offen
    s_add_u32 m0, s97, 0
    s_nop 0
    buffer_load_dwordx4 v16, s[4:7], s32 offen lds
    buffer_load_dwordx4 v17, s[4:7], s32 offen offset:1024 lds
    s_add_u32 m0, s97, 16384
    s_nop 0
    buffer_load_dwordx4 v18, s[8:11], s40 offen lds
    s_add_u32 m0, s97, 17408
    s_nop 0
    buffer_load_dwordx4 v20, s[28:31], s3 offen lds
    s_cmp_lg_u32 s96, 7168
    s_cbranch_scc1 .Lcp24
    s_getpc_b64 s[90:91]
    s_add_u32 s90, s90, parallel_sum__linear_kernel_hedgehog__dense_activation_squared_relu__prompt_kernel@rel32@lo+4
    s_addc_u32 s91, s91, parallel_sum__linear_kernel_hedgehog__dense_activation_squared_relu__prompt_kernel@rel32@hi+12
    s_lshr_b32 s92, s2, 3
    s_mul_i32 s92, s92, 1536
    v_min_u32 v119, 11, v1
    v_lshl_add_u32 v119, v119, 7, s92
    v_min_u32 v119, (.Lend - parallel_sum__linear_kernel_hedgehog__dense_activation_squared_relu__prompt_kernel), v119
    global_load_dword v245, v119, s[90:91]
.Lcp24:
    s_lshl_b32 s3, s2, 7
    s_lshr_b32 s34, s96, 4
    s_add_u32 s34, s34, 32768
    s_load_dwordx16 s[64:79], s[100:101], s34
    s_add_u32 s34, s3, 64
    s_load_dwordx16 s[48:63], s[100:101], s34
    s_bfe_u32 s34, s2, 0x30003
    s_lshl_b32 s34, s34, 2
    s_lshr_b32 s35, s2, 6
    s_add_u32 s34, s34, s35
    s_lshl_b32 s34, s34, 9
    s_lshr_b32 s35, s96, 11
    s_lshl_b32 s35, s35, 7
    s_add_u32 s34, s34, s35
    s_add_u32 s34, s34, 33280
    s_load_dword s88, s[100:101], s34
    s_add_u32 s34, s34, 64
    s_load_dword s89, s[100:101], s34
    s_nop 0
    s_load_dwordx16 s[32:47], s[100:101], s3
    s_mov_b32 s14, 268435456
    s_mov_b32 s15, 0x20000
    s_mov_b32 s18, 256
    s_mov_b32 s19, 0x20000
    s_mov_b32 s22, 1409024
    s_mov_b32 s23, 0x20000
    s_mov_b32 s26, 1966080
    s_mov_b32 s27, 0x20000
    s_mov_b32 s86, 2752
    s_mov_b32 s87, 0x20000
    s_sub_u32 s24, s24, 1441792
    s_subb_u32 s25, s25, 0
    s_lshr_b32 s98, s98, 2
    v_and_b32 v2, 31, v1
    v_lshrrev_b32 v3, 5, v1
    v_mul_u32_u24 v19, 2752, v112
    v_and_b32 v113, 0x70, v113
    v_bfe_u32 v84, v1, 1, 3
    v_add_u32 v19, v19, v113
    v_xor_b32 v84, v84, v3
    v_bfe_u32 v114, v1, 2, 2
    v_lshlrev_b32 v87, 7, v114
    v_lshrrev_b32 v114, 1, v114
    v_xor_b32 v114, s98, v114
    v_lshl_add_u32 v87, v114, 6, v87
    v_bfe_u32 v114, v1, 4, 1
    v_lshl_add_u32 v87, v114, 5, v87
    v_and_b32 v114, 3, v1
    v_lshl_add_u32 v87, v114, 3, v87
    v_lshl_add_u32 v86, v3, 10, v87
    v_lshl_add_u32 v87, v3, 11, v87
    v_add_u32 v86, 98304, v86
    v_add_u32 v87, 16384, v87
    v_bfe_u32 v120, v1, 2, 2
    v_lshl_add_u32 v120, v3, 2, v120
    v_and_b32 v121, 3, v1
    v_lshlrev_b32 v120, 5, v120
    v_lshl_add_u32 v120, v121, 3, v120
    v_bfe_u32 v123, v1, 4, 1
    s_lshl_b32 s3, s98, 10
    s_add_u32 s3, s3, 131072
    v_lshl_add_u32 v120, v123, 9, v120
    v_add_u32 v120, s3, v120
    v_add_u32 v123, -1, v123
    v_lshlrev_b32 v121, 1, v2
    v_xor_b32 v122, 1, v3
    v_lshl_add_u32 v121, v122, 7, v121
    v_mul_u32_u24 v114, 2752, v1
    v_mov_b32 v83, 0x3f803f80
    v_cmp_eq_u32 vcc, 0, v2
    s_nop 1
    v_cndmask_b32_e64 v64, 0, v83, vcc
    v_cmp_eq_u32 vcc, 20, v2
    s_nop 1
    v_cndmask_b32_e64 v64, v64, v83, vcc
    v_cmp_eq_u32 vcc, 8, v2
    s_nop 1
    v_cndmask_b32_e64 v68, 0, v83, vcc
    v_cmp_eq_u32 vcc, 28, v2
    s_nop 1
    v_cndmask_b32_e64 v68, v68, v83, vcc
    v_mov_b32 v65, v64
    v_mov_b32 v69, v68
    v_mov_b32 v66, v64
    v_mov_b32 v70, v68
    v_mov_b32 v67, v64
    v_mov_b32 v71, v68
    s_waitcnt lgkmcnt(0)
    s_barrier
    s_bfe_u32 s3, s33, 0x30007
    s_mul_i32 s3, s3, 176128
    s_add_u32 m0, s97, 32768
    s_nop 0
    buffer_load_dwordx4 v16, s[4:7], s33 offen lds
    buffer_load_dwordx4 v17, s[4:7], s33 offen offset:1024 lds
    s_add_u32 m0, s97, 49152
    s_nop 0
    buffer_load_dwordx4 v18, s[8:11], s41 offen lds
    s_add_u32 m0, s97, 50176
    s_nop 0
    buffer_load_dwordx4 v20, s[28:31], s3 offen lds
    s_add_u32 s50, s50, s70
    v_add_u32 v19, s48, v19
    s_add_u32 s63, s63, s71
    s_add_u32 s63, s63, 33280
    s_cmp_lt_u32 s96, 2048
    s_cselect_b32 s49, s49, s62
    s_bitcmp1_b32 s96, 10
    s_cselect_b32 s3, 124, 0
    s_add_u32 s49, s49, s3
    s_cmp_lt_u32 s96, 4096
    s_cselect_b32 s49, s49, 0x20000000
    v_add_u32 v244, s49, v114
    buffer_load_ushort v246, v121, s[84:87], s50 offen
    v_and_b32 v25, 1, v1
    v_lshlrev_b32 v25, 2, v25
    buffer_load_dword v25, v25, s[16:19], 0 offen sc1
    v_lshl_add_u32 v85, v2, 7, s68
    s_add_u32 s51, s51, s64
    s_add_u32 s52, s52, s65
    s_add_u32 s53, s53, s66
    s_add_u32 s58, s58, s67
    s_add_u32 s60, s60, s64
    v_xor_b32 v4, s72, v84
    v_lshl_add_u32 v8, s76, 1, v87
    v_lshl_add_u32 v4, v4, 4, v85
    v_add_u32 v12, s76, v86
    v_xor_b32 v5, s73, v84
    v_lshl_add_u32 v9, s77, 1, v87
    v_lshl_add_u32 v5, v5, 4, v85
    v_add_u32 v13, s77, v86
    v_xor_b32 v6, s74, v84
    v_lshl_add_u32 v10, s78, 1, v87
    v_lshl_add_u32 v6, v6, 4, v85
    v_add_u32 v14, s78, v86
    v_xor_b32 v7, s75, v84
    v_lshl_add_u32 v11, s79, 1, v87
    v_lshl_add_u32 v7, v7, 4, v85
    v_add_u32 v15, s79, v86
    s_add_u32 s3, s63, 64
    s_load_dwordx16 s[64:79], s[100:101], s63
    s_load_dwordx16 s[80:95], s[100:101], s3
    s_waitcnt vmcnt(6)
    s_waitcnt lgkmcnt(0)
    s_barrier
    ds_read_b128 v[128:131], v4
    ds_read_b64_tr_b16 v[80:81], v8 offset:0
    ds_read_b64_tr_b16 v[82:83], v8 offset:512
    ds_read_b64_tr_b16 v[84:85], v8 offset:1024
    ds_read_b64_tr_b16 v[86:87], v8 offset:1536
    ds_read_b128 v[132:135], v5
    ds_read_b64_tr_b16 v[88:89], v9 offset:0
    ds_read_b64_tr_b16 v[90:91], v9 offset:512
    ds_read_b64_tr_b16 v[92:93], v9 offset:1024
    ds_read_b64_tr_b16 v[94:95], v9 offset:1536
    ds_read_b64_tr_b16 v[112:113], v120
    ds_read_b64_tr_b16 v[114:115], v120 offset:256
    s_add_u32 m0, s97, 65536
    s_waitcnt lgkmcnt(9)
    v_mfma_f32_32x32x16_bf16 v[32:47], v[80:83], v[128:131], 0
    buffer_load_dwordx4 v16, s[4:7], s34 offen lds
    ds_read_b128 v[136:139], v6
    ds_read_b64_tr_b16 v[96:97], v10 offset:0
    ds_read_b64_tr_b16 v[98:99], v10 offset:512
    ds_read_b64_tr_b16 v[100:101], v10 offset:1024
    ds_read_b64_tr_b16 v[102:103], v10 offset:1536
    v_mfma_f32_16x16x32_bf16 v[72:75], v[64:67], v[80:83], 0
    v_lshlrev_b32 v228, 16, v224
    v_and_b32 v229, 0xffff0000, v224
    v_lshlrev_b32 v230, 16, v225
    v_and_b32 v231, 0xffff0000, v225
    v_lshlrev_b32 v232, 16, v226
    v_and_b32 v233, 0xffff0000, v226
    v_lshlrev_b32 v234, 16, v227
    s_add_u32 m0, s97, 65536
    s_waitcnt lgkmcnt(12)
    v_mfma_f32_32x32x16_bf16 v[48:63], v[84:87], v[128:131], 0
    buffer_load_dwordx4 v17, s[4:7], s34 offen offset:1024 lds
    ds_read_b128 v[140:143], v7
    ds_read_b64_tr_b16 v[104:105], v11 offset:0
    ds_read_b64_tr_b16 v[106:107], v11 offset:512
    ds_read_b64_tr_b16 v[108:109], v11 offset:1024
    ds_read_b64_tr_b16 v[110:111], v11 offset:1536
    v_mfma_f32_16x16x32_bf16 v[72:75], v[68:71], v[84:87], v[72:75]
    v_and_b32 v235, 0xffff0000, v227
    v_add_f32 v236, v228, v229
    v_add_f32 v237, v230, v231
    v_add_f32 v236, v236, v232
    v_add_f32 v237, v237, v233
    v_add_f32 v236, v236, v234
    v_add_f32 v237, v237, v235
    v_add_f32 v236, v236, v237
    s_add_u32 m0, s97, 81920
    s_waitcnt lgkmcnt(14)
    v_mfma_f32_32x32x16_bf16 v[32:47], v[88:91], v[132:135], v[32:47]
    buffer_load_dwordx4 v18, s[8:11], s42 offen lds
    v_add_f32_dpp v236, v236, v236 row_ror:8 row_mask:0xf bank_mask:0xf
    s_nop 1
    v_add_f32_dpp v236, v236, v236 row_ror:4 row_mask:0xf bank_mask:0xf
    s_nop 1
    v_add_f32_dpp v236, v236, v236 row_ror:2 row_mask:0xf bank_mask:0xf
    s_nop 1
    v_add_f32_dpp v236, v236, v236 row_ror:1 row_mask:0xf bank_mask:0xf
    v_mov_b32 v237, v236
    s_nop 1
    v_permlane16_swap_b32 v236, v237
    v_add_f32 v236, v236, v237
    s_add_u32 m0, s97, 82944
    s_bfe_u32 s62, s34, 0x30007
    s_mul_i32 s62, s62, 176128
    s_waitcnt lgkmcnt(12)
    v_mfma_f32_32x32x16_bf16 v[48:63], v[92:95], v[132:135], v[48:63]
    buffer_load_dwordx4 v20, s[28:31], s62 offen lds
    v_mov_b32 v237, v236
    s_nop 1
    v_permlane32_swap_b32 v236, v237
    v_add_f32 v236, v236, v237
    v_mul_f32 v238, 0x3b000000, v236
    v_sub_f32 v228, v228, v238
    v_sub_f32 v229, v229, v238
    v_sub_f32 v230, v230, v238
    v_sub_f32 v231, v231, v238
    s_add_u32 m0, s97, 98304
    s_waitcnt lgkmcnt(7)
    v_mfma_f32_32x32x16_bf16 v[32:47], v[96:99], v[136:139], v[32:47]
    buffer_load_dwordx4 v16, s[4:7], s35 offen lds
    s_waitcnt vmcnt(7)
    s_barrier
    v_add_u32 v4, 0x8000, v4
    v_add_u32 v8, 0x8000, v8
    ds_read_b128 v[144:147], v4
    ds_read_b64_tr_b16 v[80:81], v8 offset:0
    ds_read_b64_tr_b16 v[82:83], v8 offset:512
    ds_read_b64_tr_b16 v[84:85], v8 offset:1024
    ds_read_b64_tr_b16 v[86:87], v8 offset:1536
    v_sub_f32 v232, v232, v238
    v_sub_f32 v233, v233, v238
    v_sub_f32 v234, v234, v238
    v_sub_f32 v235, v235, v238
    v_mul_f32 v236, v228, v228
    v_mul_f32 v237, v229, v229
    v_fmac_f32 v236, v230, v230
    v_fmac_f32 v237, v231, v231
    s_add_u32 m0, s97, 98304
    s_waitcnt lgkmcnt(10)
    v_mfma_f32_32x32x16_bf16 v[48:63], v[100:103], v[136:139], v[48:63]
    buffer_load_dwordx4 v17, s[4:7], s35 offen offset:1024 lds
    v_add_u32 v5, 0x8000, v5
    v_add_u32 v9, 0x8000, v9
    ds_read_b128 v[148:151], v5
    ds_read_b64_tr_b16 v[88:89], v9 offset:0
    ds_read_b64_tr_b16 v[90:91], v9 offset:512
    ds_read_b64_tr_b16 v[92:93], v9 offset:1024
    ds_read_b64_tr_b16 v[94:95], v9 offset:1536
    v_fmac_f32 v236, v232, v232
    v_fmac_f32 v237, v233, v233
    v_fmac_f32 v236, v234, v234
    v_fmac_f32 v237, v235, v235
    v_add_f32 v236, v236, v237
    s_nop 1
    v_add_f32_dpp v236, v236, v236 row_ror:8 row_mask:0xf bank_mask:0xf
    s_nop 1
    v_add_f32_dpp v236, v236, v236 row_ror:4 row_mask:0xf bank_mask:0xf
    s_add_u32 m0, s97, 114688
    s_waitcnt lgkmcnt(12)
    v_mfma_f32_32x32x16_bf16 v[32:47], v[104:107], v[140:143], v[32:47]
    buffer_load_dwordx4 v18, s[8:11], s43 offen lds
    v_add_f32_dpp v236, v236, v236 row_ror:2 row_mask:0xf bank_mask:0xf
    s_nop 1
    v_add_f32_dpp v236, v236, v236 row_ror:1 row_mask:0xf bank_mask:0xf
    v_mov_b32 v237, v236
    s_nop 1
    v_permlane16_swap_b32 v236, v237
    v_add_f32 v236, v236, v237
    v_mov_b32 v237, v236
    s_nop 1
    v_permlane32_swap_b32 v236, v237
    v_add_f32 v236, v236, v237
    s_add_u32 m0, s97, 115712
    s_bfe_u32 s62, s35, 0x30007
    s_mul_i32 s62, s62, 176128
    s_waitcnt lgkmcnt(10)
    v_mfma_f32_32x32x16_bf16 v[48:63], v[108:111], v[140:143], v[48:63]
    buffer_load_dwordx4 v20, s[28:31], s62 offen lds
    v_mul_f32 v236, 0x3b000000, v236
    v_cvt_pk_bf16_f32 v237, v236, v236
    v_and_b32 v236, 0xffff0000, v237
    v_add_f32 v236, 0x3727c5ac, v236
    v_cvt_pk_bf16_f32 v237, v236, v236
    v_and_b32 v236, 0xffff0000, v237
    v_sqrt_f32 v236, v236
    s_nop 0
    v_cvt_pk_bf16_f32 v21, v238, v236
    s_waitcnt lgkmcnt(7)
    v_mfma_f32_32x32x16_bf16 v[32:47], v[80:83], v[144:147], v[32:47]
    v_add_u32 v6, 0x8000, v6
    v_add_u32 v10, 0x8000, v10
    ds_read_b128 v[152:155], v6
    ds_read_b64_tr_b16 v[96:97], v10 offset:0
    ds_read_b64_tr_b16 v[98:99], v10 offset:512
    ds_read_b64_tr_b16 v[100:101], v10 offset:1024
    ds_read_b64_tr_b16 v[102:103], v10 offset:1536
    v_mfma_f32_16x16x32_bf16 v[72:75], v[64:67], v[80:83], v[72:75]
    s_add_u32 m0, s97, 131072
    s_waitcnt lgkmcnt(10)
    v_mfma_f32_32x32x16_bf16 v[48:63], v[84:87], v[144:147], v[48:63]
    buffer_load_dwordx4 v16, s[4:7], s36 offen lds
    v_add_u32 v7, 0x8000, v7
    v_add_u32 v11, 0x8000, v11
    ds_read_b128 v[156:159], v7
    ds_read_b64_tr_b16 v[104:105], v11 offset:0
    ds_read_b64_tr_b16 v[106:107], v11 offset:512
    ds_read_b64_tr_b16 v[108:109], v11 offset:1024
    ds_read_b64_tr_b16 v[110:111], v11 offset:1536
    v_mfma_f32_16x16x32_bf16 v[72:75], v[68:71], v[84:87], v[72:75]
    s_waitcnt vmcnt(9)
    s_mov_b32 s3, 0
.Lnz25:
    v_readlane_b32 s100, v25, 0
    v_readlane_b32 s101, v25, 1
    s_add_u32 s3, s3, 1
    s_cmp_lg_u32 s100, 0
    s_cbranch_scc1 .Lnzok26
    s_cmp_ge_u32 s3, 20000
    s_cbranch_scc1 .Lnzok26
    s_sleep 8
    v_and_b32 v25, 1, v1
    v_lshlrev_b32 v25, 2, v25
    buffer_load_dword v25, v25, s[16:19], 0 offen sc1
    s_waitcnt vmcnt(0)
    s_branch .Lnz25
.Lnzok26:
    v_cmp_eq_u32 vcc, 0, v1
    v_mov_b32 v25, 0x20000000
    s_and_b32 s48, s2, 7
    s_lshl_b32 s48, s48, 18
    s_lshr_b32 s95, s2, 3
    s_lshl_b32 s95, s95, 13
    s_or_b32 s48, s48, s95
    s_lshr_b32 s48, s48, 7
    s_lshr_b32 s49, s96, 7
    s_add_u32 s48, s48, s49
    v_cndmask_b32_e64 v25, v25, 0, vcc
    v_mov_b32 v22, v21
    v_mov_b32 v23, s100
    s_add_u32 s48, s48, 16384
    buffer_store_dwordx2 v[22:23], v25, s[12:15], s48 offen sc1
    s_waitcnt lgkmcnt(12)
    v_mfma_f32_32x32x16_bf16 v[32:47], v[88:91], v[148:151], v[32:47]
    s_add_u32 m0, s97, 131072
    s_waitcnt lgkmcnt(10)
    v_mfma_f32_32x32x16_bf16 v[48:63], v[92:95], v[148:151], v[48:63]
    buffer_load_dwordx4 v17, s[4:7], s36 offen offset:1024 lds
    v_and_b32 v116, v123, v112
    v_and_b32 v117, v123, v113
    v_and_b32 v118, v123, v114
    v_and_b32 v119, v123, v115
    v_xor_b32 v116, v116, v112
    v_xor_b32 v117, v117, v113
    v_xor_b32 v118, v118, v114
    v_xor_b32 v119, v119, v115
    v_xor_b32 v112, v116, v112
    v_xor_b32 v113, v117, v113
    v_xor_b32 v114, v118, v114
    v_xor_b32 v115, v119, v115
    s_waitcnt lgkmcnt(7)
    v_mfma_f32_32x32x16_bf16 v[32:47], v[96:99], v[152:155], v[32:47]
    s_waitcnt vmcnt(7)
    s_barrier
    v_add_u32 v4, 0x8000, v4
    v_add_u32 v8, 0x8000, v8
    ds_read_b128 v[160:163], v4
    ds_read_b64_tr_b16 v[80:81], v8 offset:0
    ds_read_b64_tr_b16 v[82:83], v8 offset:512
    ds_read_b64_tr_b16 v[84:85], v8 offset:1024
    ds_read_b64_tr_b16 v[86:87], v8 offset:1536
    s_add_u32 m0, s97, 147456
    s_waitcnt lgkmcnt(10)
    v_mfma_f32_32x32x16_bf16 v[48:63], v[100:103], v[152:155], v[48:63]
    buffer_load_dwordx4 v18, s[8:11], s44 offen lds
    v_add_u32 v5, 0x8000, v5
    v_add_u32 v9, 0x8000, v9
    ds_read_b128 v[164:167], v5
    ds_read_b64_tr_b16 v[88:89], v9 offset:0
    ds_read_b64_tr_b16 v[90:91], v9 offset:512
    ds_read_b64_tr_b16 v[92:93], v9 offset:1024
    ds_read_b64_tr_b16 v[94:95], v9 offset:1536
    s_waitcnt lgkmcnt(12)
    v_mfma_f32_32x32x16_bf16 v[32:47], v[104:107], v[156:159], v[32:47]
    s_add_u32 m0, s97, 148480
    s_bfe_u32 s62, s36, 0x30007
    s_mul_i32 s62, s62, 176128
    s_waitcnt lgkmcnt(10)
    v_mfma_f32_32x32x16_bf16 v[48:63], v[108:111], v[156:159], v[48:63]
    buffer_load_dwordx4 v20, s[28:31], s62 offen lds
    v_lshlrev_b32 v26, 7, v1
    v_cmp_gt_u32 vcc, 43, v1
    v_mov_b32 v27, 0x20000000
    s_sub_u32 s49, s2, 128
    s_lshl_b32 s49, s49, 1
    s_bfe_u32 s48, s96, 0x1000a
    s_add_u32 s49, s49, s48
    s_mul_i32 s48, s49, 5504
    v_cndmask_b32_e64 v28, v27, v26, vcc
    v_cmp_gt_u32 vcc, 16, v1
    s_lshl_b32 s49, s49, 11
    s_add_u32 s49, s49, 1441792
    v_cndmask_b32_e64 v27, v27, v26, vcc
    s_lshr_b32 s50, s96, 11
    s_cmp_eq_u32 s50, 2
    s_cselect_b32 s48, s48, 0x20000000
    s_cmp_eq_u32 s50, 3
    s_cselect_b32 s49, s49, 0x20000000
    buffer_load_dword v245, v244, s[28:31], 0 offen
    buffer_load_dword v245, v28, s[20:23], s48 offen
    buffer_load_dword v245, v27, s[24:27], s49 offen
    s_waitcnt lgkmcnt(7)
    v_mfma_f32_32x32x16_bf16 v[32:47], v[80:83], v[160:163], v[32:47]
    v_add_u32 v6, 0x8000, v6
    v_add_u32 v10, 0x8000, v10
    ds_read_b128 v[168:171], v6
    ds_read_b64_tr_b16 v[96:97], v10 offset:0
    ds_read_b64_tr_b16 v[98:99], v10 offset:512
    ds_read_b64_tr_b16 v[100:101], v10 offset:1024
    ds_read_b64_tr_b16 v[102:103], v10 offset:1536
    v_mfma_f32_16x16x32_bf16 v[72:75], v[64:67], v[80:83], v[72:75]
    s_add_u32 m0, s97, 0
    s_waitcnt lgkmcnt(10)
    v_mfma_f32_32x32x16_bf16 v[48:63], v[84:87], v[160:163], v[48:63]
    buffer_load_dwordx4 v16, s[4:7], s37 offen lds
    v_add_u32 v7, 0x8000, v7
    v_add_u32 v11, 0x8000, v11
    ds_read_b128 v[172:175], v7
    ds_read_b64_tr_b16 v[104:105], v11 offset:0
    ds_read_b64_tr_b16 v[106:107], v11 offset:512
    ds_read_b64_tr_b16 v[108:109], v11 offset:1024
    ds_read_b64_tr_b16 v[110:111], v11 offset:1536
    v_mfma_f32_16x16x32_bf16 v[72:75], v[68:71], v[84:87], v[72:75]
    s_waitcnt lgkmcnt(12)
    v_mfma_f32_32x32x16_bf16 v[32:47], v[88:91], v[164:167], v[32:47]
    s_add_u32 m0, s97, 0
    s_waitcnt lgkmcnt(10)
    v_mfma_f32_32x32x16_bf16 v[48:63], v[92:95], v[164:167], v[48:63]
    buffer_load_dwordx4 v17, s[4:7], s37 offen offset:1024 lds
    s_waitcnt lgkmcnt(7)
    v_mfma_f32_32x32x16_bf16 v[32:47], v[96:99], v[168:171], v[32:47]
    s_waitcnt vmcnt(10)
    s_barrier
    v_add_u32 v4, 0x8000, v4
    v_add_u32 v8, 0x8000, v8
    ds_read_b128 v[176:179], v4
    ds_read_b64_tr_b16 v[80:81], v8 offset:0
    ds_read_b64_tr_b16 v[82:83], v8 offset:512
    ds_read_b64_tr_b16 v[84:85], v8 offset:1024
    ds_read_b64_tr_b16 v[86:87], v8 offset:1536
    s_add_u32 m0, s97, 16384
    s_waitcnt lgkmcnt(10)
    v_mfma_f32_32x32x16_bf16 v[48:63], v[100:103], v[168:171], v[48:63]
    buffer_load_dwordx4 v18, s[8:11], s45 offen lds
    v_add_u32 v5, 0x8000, v5
    v_add_u32 v9, 0x8000, v9
    ds_read_b128 v[180:183], v5
    ds_read_b64_tr_b16 v[88:89], v9 offset:0
    ds_read_b64_tr_b16 v[90:91], v9 offset:512
    ds_read_b64_tr_b16 v[92:93], v9 offset:1024
    ds_read_b64_tr_b16 v[94:95], v9 offset:1536
    s_waitcnt lgkmcnt(12)
    v_mfma_f32_32x32x16_bf16 v[32:47], v[104:107], v[172:175], v[32:47]
    s_add_u32 m0, s97, 17408
    s_bfe_u32 s62, s37, 0x30007
    s_mul_i32 s62, s62, 176128
    s_waitcnt lgkmcnt(10)
    v_mfma_f32_32x32x16_bf16 v[48:63], v[108:111], v[172:175], v[48:63]
    buffer_load_dwordx4 v20, s[28:31], s62 offen lds
    s_waitcnt lgkmcnt(7)
    v_mfma_f32_32x32x16_bf16 v[32:47], v[80:83], v[176:179], v[32:47]
    v_add_u32 v6, 0x8000, v6
    v_add_u32 v10, 0x8000, v10
    ds_read_b128 v[184:187], v6
    ds_read_b64_tr_b16 v[96:97], v10 offset:0
    ds_read_b64_tr_b16 v[98:99], v10 offset:512
    ds_read_b64_tr_b16 v[100:101], v10 offset:1024
    ds_read_b64_tr_b16 v[102:103], v10 offset:1536
    v_mfma_f32_16x16x32_bf16 v[72:75], v[64:67], v[80:83], v[72:75]
    s_add_u32 m0, s97, 32768
    s_waitcnt lgkmcnt(10)
    v_mfma_f32_32x32x16_bf16 v[48:63], v[84:87], v[176:179], v[48:63]
    buffer_load_dwordx4 v16, s[4:7], s38 offen lds
    v_add_u32 v7, 0x8000, v7
    v_add_u32 v11, 0x8000, v11
    ds_read_b128 v[188:191], v7
    ds_read_b64_tr_b16 v[104:105], v11 offset:0
    ds_read_b64_tr_b16 v[106:107], v11 offset:512
    ds_read_b64_tr_b16 v[108:109], v11 offset:1024
    ds_read_b64_tr_b16 v[110:111], v11 offset:1536
    v_mfma_f32_16x16x32_bf16 v[72:75], v[68:71], v[84:87], v[72:75]
    s_waitcnt lgkmcnt(12)
    v_mfma_f32_32x32x16_bf16 v[32:47], v[88:91], v[180:183], v[32:47]
    v_lshlrev_b32 v127, 16, v246
    s_add_u32 m0, s97, 32768
    s_waitcnt lgkmcnt(10)
    v_mfma_f32_32x32x16_bf16 v[48:63], v[92:95], v[180:183], v[48:63]
    buffer_load_dwordx4 v17, s[4:7], s38 offen offset:1024 lds
    s_waitcnt lgkmcnt(7)
    v_mfma_f32_32x32x16_bf16 v[32:47], v[96:99], v[184:187], v[32:47]
    s_waitcnt vmcnt(9)
    s_barrier
    v_add_u32 v4, 0x8000, v4
    v_add_u32 v8, 0x8000, v8
    ds_read_b128 v[192:195], v4
    ds_read_b64_tr_b16 v[80:81], v8 offset:0
    ds_read_b64_tr_b16 v[82:83], v8 offset:512
    ds_read_b64_tr_b16 v[84:85], v8 offset:1024
    ds_read_b64_tr_b16 v[86:87], v8 offset:1536
    s_add_u32 m0, s97, 49152
    s_waitcnt lgkmcnt(10)
    v_mfma_f32_32x32x16_bf16 v[48:63], v[100:103], v[184:187], v[48:63]
    buffer_load_dwordx4 v18, s[8:11], s46 offen lds
    v_add_u32 v5, 0x8000, v5
    v_add_u32 v9, 0x8000, v9
    ds_read_b128 v[196:199], v5
    ds_read_b64_tr_b16 v[88:89], v9 offset:0
    ds_read_b64_tr_b16 v[90:91], v9 offset:512
    ds_read_b64_tr_b16 v[92:93], v9 offset:1024
    ds_read_b64_tr_b16 v[94:95], v9 offset:1536
    s_waitcnt lgkmcnt(12)
    v_mfma_f32_32x32x16_bf16 v[32:47], v[104:107], v[188:191], v[32:47]
    s_add_u32 m0, s97, 50176
    s_bfe_u32 s62, s38, 0x30007
    s_mul_i32 s62, s62, 176128
    s_waitcnt lgkmcnt(10)
    v_mfma_f32_32x32x16_bf16 v[48:63], v[108:111], v[188:191], v[48:63]
    buffer_load_dwordx4 v20, s[28:31], s62 offen lds
    s_waitcnt lgkmcnt(7)
    v_mfma_f32_32x32x16_bf16 v[32:47], v[80:83], v[192:195], v[32:47]
    v_add_u32 v6, 0x8000, v6
    v_add_u32 v10, 0x8000, v10
    ds_read_b128 v[200:203], v6
    ds_read_b64_tr_b16 v[96:97], v10 offset:0
    ds_read_b64_tr_b16 v[98:99], v10 offset:512
    ds_read_b64_tr_b16 v[100:101], v10 offset:1024
    ds_read_b64_tr_b16 v[102:103], v10 offset:1536
    v_mfma_f32_16x16x32_bf16 v[72:75], v[64:67], v[80:83], v[72:75]
    s_add_u32 m0, s97, 65536
    s_waitcnt lgkmcnt(10)
    v_mfma_f32_32x32x16_bf16 v[48:63], v[84:87], v[192:195], v[48:63]
    buffer_load_dwordx4 v16, s[4:7], s39 offen lds
    v_add_u32 v7, 0x8000, v7
    v_add_u32 v11, 0x8000, v11
    ds_read_b128 v[204:207], v7
    ds_read_b64_tr_b16 v[104:105], v11 offset:0
    ds_read_b64_tr_b16 v[106:107], v11 offset:512
    ds_read_b64_tr_b16 v[108:109], v11 offset:1024
    ds_read_b64_tr_b16 v[110:111], v11 offset:1536
    v_mfma_f32_16x16x32_bf16 v[72:75], v[68:71], v[84:87], v[72:75]
    s_waitcnt lgkmcnt(12)
    v_mfma_f32_32x32x16_bf16 v[32:47], v[88:91], v[196:199], v[32:47]
    s_add_u32 m0, s97, 65536
    s_waitcnt lgkmcnt(10)
    v_mfma_f32_32x32x16_bf16 v[48:63], v[92:95], v[196:199], v[48:63]
    buffer_load_dwordx4 v17, s[4:7], s39 offen offset:1024 lds
    s_waitcnt lgkmcnt(7)
    v_mfma_f32_32x32x16_bf16 v[32:47], v[96:99], v[200:203], v[32:47]
    s_waitcnt vmcnt(6)
    s_barrier
    v_add_u32 v4, 0xfffe0000, v4
    v_add_u32 v8, 0xfffe0000, v8
    ds_read_b128 v[208:211], v4
    ds_read_b64_tr_b16 v[80:81], v8 offset:0
    ds_read_b64_tr_b16 v[82:83], v8 offset:512
    ds_read_b64_tr_b16 v[84:85], v8 offset:1024
    ds_read_b64_tr_b16 v[86:87], v8 offset:1536
    s_add_u32 m0, s97, 81920
    s_waitcnt lgkmcnt(10)
    v_mfma_f32_32x32x16_bf16 v[48:63], v[100:103], v[200:203], v[48:63]
    buffer_load_dwordx4 v18, s[8:11], s47 offen lds
    v_add_u32 v5, 0xfffe0000, v5
    v_add_u32 v9, 0xfffe0000, v9
    ds_read_b128 v[212:215], v5
    ds_read_b64_tr_b16 v[88:89], v9 offset:0
    ds_read_b64_tr_b16 v[90:91], v9 offset:512
    ds_read_b64_tr_b16 v[92:93], v9 offset:1024
    ds_read_b64_tr_b16 v[94:95], v9 offset:1536
    s_waitcnt lgkmcnt(12)
    v_mfma_f32_32x32x16_bf16 v[32:47], v[104:107], v[204:207], v[32:47]
    s_add_u32 m0, s97, 82944
    s_bfe_u32 s62, s39, 0x30007
    s_mul_i32 s62, s62, 176128
    s_waitcnt lgkmcnt(10)
    v_mfma_f32_32x32x16_bf16 v[48:63], v[108:111], v[204:207], v[48:63]
    buffer_load_dwordx4 v20, s[28:31], s62 offen lds
    s_bfe_u32 s32, s32, 0x30007
    s_mul_i32 s32, s32, 176128
    s_bfe_u32 s33, s33, 0x30007
    s_mul_i32 s33, s33, 176128
    s_bfe_u32 s34, s34, 0x30007
    s_mul_i32 s34, s34, 176128
    s_bfe_u32 s35, s35, 0x30007
    s_mul_i32 s35, s35, 176128
    s_waitcnt lgkmcnt(7)
    v_mfma_f32_32x32x16_bf16 v[32:47], v[80:83], v[208:211], v[32:47]
    v_add_u32 v6, 0xfffe0000, v6
    v_add_u32 v10, 0xfffe0000, v10
    ds_read_b128 v[216:219], v6
    ds_read_b64_tr_b16 v[96:97], v10 offset:0
    ds_read_b64_tr_b16 v[98:99], v10 offset:512
    ds_read_b64_tr_b16 v[100:101], v10 offset:1024
    ds_read_b64_tr_b16 v[102:103], v10 offset:1536
    v_mfma_f32_16x16x32_bf16 v[72:75], v[64:67], v[80:83], v[72:75]
    s_add_u32 m0, s96, 98304
    s_waitcnt lgkmcnt(10)
    v_mfma_f32_32x32x16_bf16 v[48:63], v[84:87], v[208:211], v[48:63]
    buffer_load_dwordx4 v19, s[28:31], s32 offen lds
    v_add_u32 v7, 0xfffe0000, v7
    v_add_u32 v11, 0xfffe0000, v11
    ds_read_b128 v[220:223], v7
    ds_read_b64_tr_b16 v[104:105], v11 offset:0
    ds_read_b64_tr_b16 v[106:107], v11 offset:512
    ds_read_b64_tr_b16 v[108:109], v11 offset:1024
    ds_read_b64_tr_b16 v[110:111], v11 offset:1536
    v_mfma_f32_16x16x32_bf16 v[72:75], v[68:71], v[84:87], v[72:75]
    s_waitcnt lgkmcnt(12)
    v_mfma_f32_32x32x16_bf16 v[32:47], v[88:91], v[212:215], v[32:47]
    s_add_u32 m0, s96, 106496
    s_waitcnt lgkmcnt(10)
    v_mfma_f32_32x32x16_bf16 v[48:63], v[92:95], v[212:215], v[48:63]
    buffer_load_dwordx4 v19, s[28:31], s33 offen lds
    s_bfe_u32 s36, s36, 0x30007
    s_mul_i32 s36, s36, 176128
    s_bfe_u32 s37, s37, 0x30007
    s_mul_i32 s37, s37, 176128
    s_bfe_u32 s38, s38, 0x30007
    s_mul_i32 s38, s38, 176128
    s_bfe_u32 s39, s39, 0x30007
    s_mul_i32 s39, s39, 176128
    s_waitcnt lgkmcnt(7)
    v_mfma_f32_32x32x16_bf16 v[32:47], v[96:99], v[216:219], v[32:47]
    s_waitcnt vmcnt(6)
    s_barrier
    v_add_u32 v4, 0x8000, v4
    v_add_u32 v8, 0x8000, v8
    ds_read_b128 v[224:227], v4
    ds_read_b64_tr_b16 v[80:81], v8 offset:0
    ds_read_b64_tr_b16 v[82:83], v8 offset:512
    ds_read_b64_tr_b16 v[84:85], v8 offset:1024
    ds_read_b64_tr_b16 v[86:87], v8 offset:1536
    s_add_u32 m0, s96, 114688
    s_waitcnt lgkmcnt(10)
    v_mfma_f32_32x32x16_bf16 v[48:63], v[100:103], v[216:219], v[48:63]
    buffer_load_dwordx4 v19, s[28:31], s34 offen lds
    v_add_u32 v5, 0x8000, v5
    v_add_u32 v9, 0x8000, v9
    ds_read_b128 v[228:231], v5
    ds_read_b64_tr_b16 v[88:89], v9 offset:0
    ds_read_b64_tr_b16 v[90:91], v9 offset:512
    ds_read_b64_tr_b16 v[92:93], v9 offset:1024
    ds_read_b64_tr_b16 v[94:95], v9 offset:1536
    s_waitcnt lgkmcnt(12)
    v_mfma_f32_32x32x16_bf16 v[32:47], v[104:107], v[220:223], v[32:47]
    s_add_u32 m0, s96, 122880
    s_waitcnt lgkmcnt(10)
    v_mfma_f32_32x32x16_bf16 v[48:63], v[108:111], v[220:223], v[48:63]
    buffer_load_dwordx4 v19, s[28:31], s35 offen lds
    v_lshlrev_b32 v21, 3, v2
    buffer_load_dwordx2 v[22:23], v21, s[12:15], s52 offen sc1
    s_add_u32 m0, s96, 131072
    s_waitcnt lgkmcnt(7)
    v_mfma_f32_32x32x16_bf16 v[32:47], v[80:83], v[224:227], v[32:47]
    buffer_load_dwordx4 v19, s[28:31], s36 offen lds
    v_add_u32 v6, 0x8000, v6
    v_add_u32 v10, 0x8000, v10
    ds_read_b128 v[232:235], v6
    ds_read_b64_tr_b16 v[96:97], v10 offset:0
    ds_read_b64_tr_b16 v[98:99], v10 offset:512
    ds_read_b64_tr_b16 v[100:101], v10 offset:1024
    ds_read_b64_tr_b16 v[102:103], v10 offset:1536
    v_mfma_f32_16x16x32_bf16 v[72:75], v[64:67], v[80:83], v[72:75]
    s_waitcnt lgkmcnt(10)
    v_mfma_f32_32x32x16_bf16 v[48:63], v[84:87], v[224:227], v[48:63]
    v_add_u32 v7, 0x8000, v7
    v_add_u32 v11, 0x8000, v11
    ds_read_b128 v[236:239], v7
    ds_read_b64_tr_b16 v[104:105], v11 offset:0
    ds_read_b64_tr_b16 v[106:107], v11 offset:512
    ds_read_b64_tr_b16 v[108:109], v11 offset:1024
    ds_read_b64_tr_b16 v[110:111], v11 offset:1536
    v_mfma_f32_16x16x32_bf16 v[72:75], v[68:71], v[84:87], v[72:75]
    v_bfe_u32 v17, v1, 4, 1
    v_and_b32 v16, 7, v1
    v_lshlrev_b32 v17, 2, v17
    s_bfe_u32 s48, s96, 0x1000a
    v_xor_b32 v16, v16, v17
    s_lshl_b32 s48, s48, 13
    v_lshrrev_b32 v17, 3, v1
    s_add_u32 s48, s48, s61
    v_lshl_add_u32 v16, v16, 4, s48
    v_lshl_add_u32 v16, v17, 10, v16
    s_add_u32 m0, s96, 139264
    s_waitcnt lgkmcnt(12)
    v_mfma_f32_32x32x16_bf16 v[32:47], v[88:91], v[228:231], v[32:47]
    buffer_load_dwordx4 v19, s[28:31], s37 offen lds
    s_waitcnt lgkmcnt(10)
    v_mfma_f32_32x32x16_bf16 v[48:63], v[92:95], v[228:231], v[48:63]
    s_add_u32 m0, s96, 147456
    s_waitcnt lgkmcnt(7)
    v_mfma_f32_32x32x16_bf16 v[32:47], v[96:99], v[232:235], v[32:47]
    buffer_load_dwordx4 v19, s[28:31], s38 offen lds
    s_waitcnt vmcnt(8)
    s_barrier
    v_add_u32 v4, 0x8000, v4
    v_add_u32 v8, 0x8000, v8
    ds_read_b128 v[240:243], v4
    ds_read_b64_tr_b16 v[80:81], v8 offset:0
    ds_read_b64_tr_b16 v[82:83], v8 offset:512
    ds_read_b64_tr_b16 v[84:85], v8 offset:1024
    ds_read_b64_tr_b16 v[86:87], v8 offset:1536
    s_waitcnt lgkmcnt(10)
    v_mfma_f32_32x32x16_bf16 v[48:63], v[100:103], v[232:235], v[48:63]
    v_add_u32 v5, 0x8000, v5
    v_add_u32 v9, 0x8000, v9
    ds_read_b128 v[244:247], v5
    ds_read_b64_tr_b16 v[88:89], v9 offset:0
    ds_read_b64_tr_b16 v[90:91], v9 offset:512
    ds_read_b64_tr_b16 v[92:93], v9 offset:1024
    ds_read_b64_tr_b16 v[94:95], v9 offset:1536
    s_add_u32 m0, s96, 155648
    s_waitcnt lgkmcnt(12)
    v_mfma_f32_32x32x16_bf16 v[32:47], v[104:107], v[236:239], v[32:47]
    buffer_load_dwordx4 v19, s[28:31], s39 offen lds
    s_waitcnt lgkmcnt(10)
    v_mfma_f32_32x32x16_bf16 v[48:63], v[108:111], v[236:239], v[48:63]
    s_lshr_b32 s48, s96, 2
    s_lshl_b32 s49, s98, 10
    s_add_u32 s48, s48, 24576
    s_add_u32 s49, s49, 24576
    v_lshl_add_u32 v17, v1, 2, s48
    v_lshl_add_u32 v18, v1, 2, s49
    v_add_u32 v20, -1, v3
    s_add_u32 m0, s96, 0
    s_lshl_b32 s63, s64, 4
    buffer_load_dwordx4 v16, s[20:23], s63 offen lds
    s_waitcnt lgkmcnt(7)
    v_mfma_f32_32x32x16_bf16 v[32:47], v[80:83], v[240:243], v[32:47]
    v_add_u32 v6, 0x8000, v6
    v_add_u32 v10, 0x8000, v10
    ds_read_b128 v[248:251], v6
    ds_read_b64_tr_b16 v[96:97], v10 offset:0
    ds_read_b64_tr_b16 v[98:99], v10 offset:512
    ds_read_b64_tr_b16 v[100:101], v10 offset:1024
    ds_read_b64_tr_b16 v[102:103], v10 offset:1536
    v_mfma_f32_16x16x32_bf16 v[76:79], v[64:67], v[80:83], 0
    ds_write_b32 v17, v72 offset:6144
    v_mov_b32 v26, 28672
    v_mov_b32 v28, 0
    v_mov_b32 v29, 0
    ds_write_b64 v26, v[28:29]
    v_and_b32 v125, v20, v127
    v_xor_b32 v127, v125, v127
    s_waitcnt lgkmcnt(12)
    v_mfma_f32_32x32x16_bf16 v[48:63], v[84:87], v[240:243], v[48:63]
    v_add_u32 v7, 0x8000, v7
    v_add_u32 v11, 0x8000, v11
    ds_read_b128 v[252:255], v7
    ds_read_b64_tr_b16 v[104:105], v11 offset:0
    ds_read_b64_tr_b16 v[106:107], v11 offset:512
    ds_read_b64_tr_b16 v[108:109], v11 offset:1024
    ds_read_b64_tr_b16 v[110:111], v11 offset:1536
    v_mfma_f32_16x16x32_bf16 v[76:79], v[68:71], v[84:87], v[76:79]
    s_waitcnt vmcnt(5)
    s_mov_b32 s3, 0
.Lgr27:
    v_cmp_eq_u32 vcc, s100, v23
    s_add_u32 s3, s3, 1
    s_cmp_eq_u64 vcc, exec
    s_cbranch_scc1 .Lgrok28
    s_cmp_ge_u32 s3, 20000
    s_cbranch_scc1 .Lgrok28
    s_sleep 4
    buffer_load_dwordx2 v[22:23], v21, s[12:15], s52 offen sc1
    s_waitcnt vmcnt(0)
    s_branch .Lgr27
.Lgrok28:
    v_xor_b32 v27, 0x8000, v22
    v_and_b32 v23, 0xffff0000, v22
    s_mov_b32 s48, 0x01000100
    v_rcp_f32 v21, v23
    v_perm_b32 v26, v27, v27, s48
    v_mov_b32 v29, v27
    v_mov_b32 v28, v26
    v_mul_f32 v24, 0x3fb8aa3b, v21
    s_waitcnt lgkmcnt(14)
    v_mfma_f32_32x32x16_bf16 v[32:47], v[88:91], v[244:247], v[32:47]
    v_mfma_f32_16x16x32_bf16 v[76:79], v[64:67], v[88:91], v[76:79]
    s_waitcnt lgkmcnt(12)
    v_mfma_f32_32x32x16_bf16 v[48:63], v[92:95], v[244:247], v[48:63]
    v_mfma_f32_16x16x32_bf16 v[76:79], v[68:71], v[92:95], v[76:79]
    s_add_u32 m0, s96, 8192
    s_lshl_b32 s63, s65, 4
    buffer_load_dwordx4 v16, s[20:23], s63 offen lds
    s_waitcnt lgkmcnt(9)
    v_mfma_f32_32x32x16_bf16 v[32:47], v[96:99], v[248:251], v[32:47]
    v_mfma_f32_16x16x32_bf16 v[76:79], v[64:67], v[96:99], v[76:79]
    s_waitcnt vmcnt(2)
    s_waitcnt lgkmcnt(5)
    s_barrier
    v_mfma_f32_32x32x16_bf16 v[48:63], v[100:103], v[248:251], v[48:63]
    v_mfma_f32_16x16x32_bf16 v[76:79], v[68:71], v[100:103], v[76:79]
    ds_read_b32 v72, v18 offset:6144
    ds_read_b32 v73, v18 offset:6400
    ds_read_b32 v74, v18 offset:6656
    ds_read_b32 v75, v18 offset:6912
    s_waitcnt lgkmcnt(6)
    v_mfma_f32_32x32x16_bf16 v[32:47], v[104:107], v[252:255], v[32:47]
    v_mfma_f32_16x16x32_bf16 v[76:79], v[64:67], v[104:107], v[76:79]
    s_waitcnt lgkmcnt(4)
    v_mfma_f32_32x32x16_bf16 v[48:63], v[108:111], v[252:255], v[48:63]
    v_mfma_f32_16x16x32_bf16 v[76:79], v[68:71], v[108:111], v[76:79]
    s_add_u32 m0, s96, 16384
    s_lshl_b32 s63, s66, 4
    buffer_load_dwordx4 v16, s[20:23], s63 offen lds
    s_waitcnt lgkmcnt(0)
    v_add_f32 v72, v72, v73
    v_add_f32 v74, v74, v75
    v_mov_b32 v82, 0
    v_mov_b32 v83, 0
    v_add_f32 v72, v72, v74
    s_nop 2
    v_add_f32 v72, v72, v76
    v_cvt_pk_bf16_f32 v73, v72, v72
    v_and_b32 v73, 0xffff0000, v73
    v_sub_f32 v74, v72, v73
    v_cvt_pk_bf16_f32 v84, v72, v74
    v_and_b32 v73, 0xffff0000, v84
    v_sub_f32 v74, v74, v73
    v_cvt_pk_bf16_f32 v85, v74, v127
    v_and_b32 v80, v20, v84
    v_and_b32 v81, v20, v85
    v_xor_b32 v84, v80, v84
    v_xor_b32 v85, v81, v85
    v_mfma_f32_32x32x16_bf16 v[32:47], v[80:83], v[26:29], v[32:47]
    s_nop 0
    v_mfma_f32_32x32x16_bf16 v[48:63], v[82:85], v[26:29], v[48:63]
    ds_read_b64_tr_b16 v[96:97], v12 offset:0
    ds_read_b64_tr_b16 v[98:99], v12 offset:512
    ds_read_b64_tr_b16 v[100:101], v12 offset:8192
    ds_read_b64_tr_b16 v[102:103], v12 offset:8704
    ds_read_b64_tr_b16 v[104:105], v12 offset:16384
    ds_read_b64_tr_b16 v[106:107], v12 offset:16896
    ds_read_b64_tr_b16 v[108:109], v12 offset:24576
    ds_read_b64_tr_b16 v[110:111], v12 offset:25088
    v_mul_f32 v126, 0.5, v21
    v_mul_f32 v126, v126, v126
    v_cvt_pk_bf16_f32 v80, v32, v33
    v_cvt_pk_bf16_f32 v81, v34, v35
    v_cvt_pk_bf16_f32 v82, v36, v37
    v_cvt_pk_bf16_f32 v83, v38, v39
    v_cvt_pk_bf16_f32 v84, v40, v41
    v_cvt_pk_bf16_f32 v85, v42, v43
    v_cvt_pk_bf16_f32 v86, v44, v45
    v_cvt_pk_bf16_f32 v87, v46, v47
    v_mfma_f32_32x32x16_bf16 v[32:47], v[112:115], v[80:83], 0
    s_nop 0
    v_mfma_f32_32x32x16_bf16 v[32:47], v[116:119], v[84:87], v[32:47]
    s_waitcnt lgkmcnt(0)
    v_mfma_f32_16x16x32_bf16 v[68:71], v[64:67], v[96:99], 0
    v_mfma_f32_16x16x32_bf16 v[68:71], v[64:67], v[100:103], v[68:71]
    v_mfma_f32_16x16x32_bf16 v[68:71], v[64:67], v[104:107], v[68:71]
    v_mfma_f32_16x16x32_bf16 v[68:71], v[64:67], v[108:111], v[68:71]
    ds_read_b64_tr_b16 v[96:97], v12 offset:32768
    ds_read_b64_tr_b16 v[98:99], v12 offset:33280
    ds_read_b64_tr_b16 v[100:101], v12 offset:40960
    ds_read_b64_tr_b16 v[102:103], v12 offset:41472
    ds_read_b64_tr_b16 v[104:105], v12 offset:49152
    ds_read_b64_tr_b16 v[106:107], v12 offset:49664
    ds_read_b64_tr_b16 v[108:109], v12 offset:57344
    ds_read_b64_tr_b16 v[110:111], v12 offset:57856
    v_add_f32_e64 v48, v48, |v48|
    v_add_f32_e64 v49, v49, |v49|
    v_add_f32_e64 v50, v50, |v50|
    v_add_f32_e64 v51, v51, |v51|
    v_add_f32_e64 v52, v52, |v52|
    v_add_f32_e64 v53, v53, |v53|
    v_add_f32_e64 v54, v54, |v54|
    v_add_f32_e64 v55, v55, |v55|
    v_add_f32_e64 v56, v56, |v56|
    v_add_f32_e64 v57, v57, |v57|
    v_add_f32_e64 v58, v58, |v58|
    v_add_f32_e64 v59, v59, |v59|
    v_add_f32_e64 v60, v60, |v60|
    v_add_f32_e64 v61, v61, |v61|
    v_add_f32_e64 v62, v62, |v62|
    v_add_f32_e64 v63, v63, |v63|
    v_mul_f32 v48, v48, v48
    v_mul_f32 v49, v49, v49
    v_mul_f32 v50, v50, v50
    v_mul_f32 v51, v51, v51
    v_mul_f32 v52, v52, v52
    v_mul_f32 v53, v53, v53
    v_mul_f32 v54, v54, v54
    v_mul_f32 v55, v55, v55
    s_waitcnt lgkmcnt(0)
    v_mfma_f32_16x16x32_bf16 v[68:71], v[64:67], v[96:99], v[68:71]
    v_mfma_f32_16x16x32_bf16 v[68:71], v[64:67], v[100:103], v[68:71]
    v_mfma_f32_16x16x32_bf16 v[68:71], v[64:67], v[104:107], v[68:71]
    v_mfma_f32_16x16x32_bf16 v[68:71], v[64:67], v[108:111], v[68:71]
    v_mul_f32 v56, v56, v56
    v_mul_f32 v57, v57, v57
    v_mul_f32 v58, v58, v58
    v_mul_f32 v59, v59, v59
    v_mul_f32 v60, v60, v60
    v_mul_f32 v61, v61, v61
    v_mul_f32 v62, v62, v62
    v_mul_f32 v63, v63, v63
    v_mul_f32 v48, v48, v126
    v_mul_f32 v49, v49, v126
    v_mul_f32 v50, v50, v126
    v_mul_f32 v51, v51, v126
    v_mul_f32 v52, v52, v126
    v_mul_f32 v53, v53, v126
    v_mul_f32 v54, v54, v126
    v_mul_f32 v55, v55, v126
    ds_write_b32 v17, v68 offset:0
    ds_read_b64_tr_b16 v[80:81], v12 offset:0
    ds_read_b64_tr_b16 v[82:83], v12 offset:512
    ds_read_b64_tr_b16 v[84:85], v13 offset:0
    ds_read_b64_tr_b16 v[86:87], v13 offset:512
    ds_read_b64_tr_b16 v[88:89], v14 offset:0
    ds_read_b64_tr_b16 v[90:91], v14 offset:512
    ds_read_b64_tr_b16 v[92:93], v15 offset:0
    ds_read_b64_tr_b16 v[94:95], v15 offset:512
    ds_read_b64_tr_b16 v[96:97], v12 offset:8192
    ds_read_b64_tr_b16 v[98:99], v12 offset:8704
    ds_read_b64_tr_b16 v[100:101], v13 offset:8192
    ds_read_b64_tr_b16 v[102:103], v13 offset:8704
    s_waitcnt lgkmcnt(12)
    s_waitcnt lgkmcnt(8)
    v_mfma_f32_32x32x16_bf16 v[64:79], v[80:83], v[128:131], 0
    ds_read_b64_tr_b16 v[104:105], v14 offset:8192
    ds_read_b64_tr_b16 v[106:107], v14 offset:8704
    v_mul_f32 v56, v56, v126
    v_mul_f32 v57, v57, v126
    v_mul_f32 v58, v58, v126
    v_mul_f32 v59, v59, v126
    v_mfma_f32_32x32x16_bf16 v[64:79], v[84:87], v[132:135], v[64:79]
    ds_read_b64_tr_b16 v[108:109], v15 offset:8192
    ds_read_b64_tr_b16 v[110:111], v15 offset:8704
    v_mul_f32 v60, v60, v126
    v_mul_f32 v61, v61, v126
    v_mul_f32 v62, v62, v126
    v_mul_f32 v63, v63, v126
    v_cvt_pk_bf16_f32 v48, v48, v49
    s_waitcnt lgkmcnt(8)
    v_mfma_f32_32x32x16_bf16 v[64:79], v[88:91], v[136:139], v[64:79]
    ds_read_b64_tr_b16 v[80:81], v12 offset:16384
    ds_read_b64_tr_b16 v[82:83], v12 offset:16896
    v_cvt_pk_bf16_f32 v49, v50, v51
    v_cvt_pk_bf16_f32 v50, v52, v53
    v_cvt_pk_bf16_f32 v51, v54, v55
    v_cvt_pk_bf16_f32 v52, v56, v57
    v_mfma_f32_32x32x16_bf16 v[64:79], v[92:95], v[140:143], v[64:79]
    ds_read_b64_tr_b16 v[84:85], v13 offset:16384
    ds_read_b64_tr_b16 v[86:87], v13 offset:16896
    v_cvt_pk_bf16_f32 v53, v58, v59
    v_cvt_pk_bf16_f32 v54, v60, v61
    v_cvt_pk_bf16_f32 v55, v62, v63
    buffer_store_dwordx4 v[48:51], v30, s[12:15], s51 offen offset:0 sc1
    buffer_store_dwordx4 v[52:55], v30, s[12:15], s51 offen offset:1024 sc1
    s_barrier
    ds_read_b32 v116, v18 offset:0
    ds_read_b32 v117, v18 offset:256
    ds_read_b32 v118, v18 offset:512
    ds_read_b32 v119, v18 offset:768
    s_waitcnt lgkmcnt(12)
    v_mfma_f32_32x32x16_bf16 v[64:79], v[96:99], v[144:147], v[64:79]
    ds_read_b64_tr_b16 v[88:89], v14 offset:16384
    ds_read_b64_tr_b16 v[90:91], v14 offset:16896
    v_mfma_f32_32x32x16_bf16 v[64:79], v[100:103], v[148:151], v[64:79]
    ds_read_b64_tr_b16 v[92:93], v15 offset:16384
    ds_read_b64_tr_b16 v[94:95], v15 offset:16896
    s_waitcnt lgkmcnt(12)
    v_mfma_f32_32x32x16_bf16 v[64:79], v[104:107], v[152:155], v[64:79]
    ds_read_b64_tr_b16 v[96:97], v12 offset:24576
    ds_read_b64_tr_b16 v[98:99], v12 offset:25088
    s_add_u32 m0, s96, 32768
    s_lshl_b32 s63, s67, 4
    buffer_load_dwordx4 v16, s[20:23], s63 offen lds
    v_mfma_f32_32x32x16_bf16 v[64:79], v[108:111], v[156:159], v[64:79]
    ds_read_b64_tr_b16 v[100:101], v13 offset:24576
    ds_read_b64_tr_b16 v[102:103], v13 offset:25088
    s_waitcnt lgkmcnt(12)
    v_mfma_f32_32x32x16_bf16 v[64:79], v[80:83], v[160:163], v[64:79]
    ds_read_b64_tr_b16 v[104:105], v14 offset:24576
    ds_read_b64_tr_b16 v[106:107], v14 offset:25088
    v_mfma_f32_32x32x16_bf16 v[64:79], v[84:87], v[164:167], v[64:79]
    ds_read_b64_tr_b16 v[108:109], v15 offset:24576
    ds_read_b64_tr_b16 v[110:111], v15 offset:25088
    s_add_u32 m0, s96, 40960
    s_lshl_b32 s63, s68, 4
    buffer_load_dwordx4 v16, s[20:23], s63 offen lds
    s_waitcnt lgkmcnt(8)
    v_mfma_f32_32x32x16_bf16 v[64:79], v[88:91], v[168:171], v[64:79]
    ds_read_b64_tr_b16 v[80:81], v12 offset:32768
    ds_read_b64_tr_b16 v[82:83], v12 offset:33280
    v_mfma_f32_32x32x16_bf16 v[64:79], v[92:95], v[172:175], v[64:79]
    ds_read_b64_tr_b16 v[84:85], v13 offset:32768
    ds_read_b64_tr_b16 v[86:87], v13 offset:33280
    s_add_u32 m0, s96, 49152
    s_lshl_b32 s63, s69, 4
    buffer_load_dwordx4 v16, s[20:23], s63 offen lds
    v_add_f32 v116, v116, v117
    v_add_f32 v118, v118, v119
    v_mov_b32 v122, 0
    v_mov_b32 v123, 0
    v_add_f32 v116, v116, v118
    v_cvt_pk_bf16_f32 v117, v116, v116
    v_and_b32 v117, 0xffff0000, v117
    v_sub_f32 v118, v116, v117
    v_cvt_pk_bf16_f32 v120, v116, v118
    v_and_b32 v117, 0xffff0000, v120
    v_sub_f32 v118, v118, v117
    v_cvt_pk_bf16_f32 v121, v118, v125
    s_waitcnt lgkmcnt(8)
    v_mfma_f32_32x32x16_bf16 v[64:79], v[96:99], v[176:179], v[64:79]
    ds_read_b64_tr_b16 v[88:89], v14 offset:32768
    ds_read_b64_tr_b16 v[90:91], v14 offset:33280
    v_mfma_f32_32x32x16_bf16 v[64:79], v[100:103], v[180:183], v[64:79]
    ds_read_b64_tr_b16 v[92:93], v15 offset:32768
    ds_read_b64_tr_b16 v[94:95], v15 offset:33280
    s_waitcnt lgkmcnt(8)
    v_mfma_f32_32x32x16_bf16 v[64:79], v[104:107], v[184:187], v[64:79]
    ds_read_b64_tr_b16 v[96:97], v12 offset:40960
    ds_read_b64_tr_b16 v[98:99], v12 offset:41472
    v_mfma_f32_32x32x16_bf16 v[64:79], v[108:111], v[188:191], v[64:79]
    ds_read_b64_tr_b16 v[100:101], v13 offset:40960
    ds_read_b64_tr_b16 v[102:103], v13 offset:41472
    s_add_u32 m0, s96, 57344
    s_lshl_b32 s63, s70, 4
    buffer_load_dwordx4 v16, s[20:23], s63 offen lds
    s_waitcnt lgkmcnt(8)
    v_mfma_f32_32x32x16_bf16 v[64:79], v[80:83], v[192:195], v[64:79]
    ds_read_b64_tr_b16 v[104:105], v14 offset:40960
    ds_read_b64_tr_b16 v[106:107], v14 offset:41472
    v_mfma_f32_32x32x16_bf16 v[64:79], v[84:87], v[196:199], v[64:79]
    ds_read_b64_tr_b16 v[108:109], v15 offset:40960
    ds_read_b64_tr_b16 v[110:111], v15 offset:41472
    s_waitcnt lgkmcnt(8)
    v_mfma_f32_32x32x16_bf16 v[64:79], v[88:91], v[200:203], v[64:79]
    ds_read_b64_tr_b16 v[80:81], v12 offset:49152
    ds_read_b64_tr_b16 v[82:83], v12 offset:49664
    s_add_u32 m0, s96, 65536
    s_lshl_b32 s63, s71, 4
    buffer_load_dwordx4 v16, s[20:23], s63 offen lds
    v_mfma_f32_32x32x16_bf16 v[64:79], v[92:95], v[204:207], v[64:79]
    ds_read_b64_tr_b16 v[84:85], v13 offset:49152
    ds_read_b64_tr_b16 v[86:87], v13 offset:49664
    s_waitcnt lgkmcnt(8)
    v_mfma_f32_32x32x16_bf16 v[64:79], v[96:99], v[208:211], v[64:79]
    ds_read_b64_tr_b16 v[88:89], v14 offset:49152
    ds_read_b64_tr_b16 v[90:91], v14 offset:49664
    v_mfma_f32_32x32x16_bf16 v[64:79], v[100:103], v[212:215], v[64:79]
    ds_read_b64_tr_b16 v[92:93], v15 offset:49152
    ds_read_b64_tr_b16 v[94:95], v15 offset:49664
    s_add_u32 m0, s96, 73728
    s_lshl_b32 s63, s72, 4
    buffer_load_dwordx4 v16, s[20:23], s63 offen lds
    s_waitcnt lgkmcnt(8)
    v_mfma_f32_32x32x16_bf16 v[64:79], v[104:107], v[216:219], v[64:79]
    ds_read_b64_tr_b16 v[96:97], v12 offset:57344
    ds_read_b64_tr_b16 v[98:99], v12 offset:57856
    v_mfma_f32_32x32x16_bf16 v[64:79], v[108:111], v[220:223], v[64:79]
    ds_read_b64_tr_b16 v[100:101], v13 offset:57344
    ds_read_b64_tr_b16 v[102:103], v13 offset:57856
    s_waitcnt lgkmcnt(8)
    v_mfma_f32_32x32x16_bf16 v[64:79], v[80:83], v[224:227], v[64:79]
    ds_read_b64_tr_b16 v[104:105], v14 offset:57344
    ds_read_b64_tr_b16 v[106:107], v14 offset:57856
    s_add_u32 m0, s96, 81920
    s_lshl_b32 s63, s73, 4
    buffer_load_dwordx4 v16, s[20:23], s63 offen lds
    v_mfma_f32_32x32x16_bf16 v[64:79], v[84:87], v[228:231], v[64:79]
    ds_read_b64_tr_b16 v[108:109], v15 offset:57344
    ds_read_b64_tr_b16 v[110:111], v15 offset:57856
    s_waitcnt lgkmcnt(8)
    v_mfma_f32_32x32x16_bf16 v[64:79], v[88:91], v[232:235], v[64:79]
    v_mfma_f32_32x32x16_bf16 v[64:79], v[92:95], v[236:239], v[64:79]
    s_add_u32 m0, s96, 90112
    s_lshl_b32 s63, s74, 4
    buffer_load_dwordx4 v16, s[20:23], s63 offen lds
    s_waitcnt lgkmcnt(4)
    v_mfma_f32_32x32x16_bf16 v[64:79], v[96:99], v[240:243], v[64:79]
    v_mfma_f32_32x32x16_bf16 v[64:79], v[100:103], v[244:247], v[64:79]
    s_waitcnt lgkmcnt(0)
    v_mfma_f32_32x32x16_bf16 v[64:79], v[104:107], v[248:251], v[64:79]
    v_mfma_f32_32x32x16_bf16 v[64:79], v[108:111], v[252:255], v[64:79]
    v_mfma_f32_32x32x16_bf16 v[64:79], v[120:123], v[26:29], v[64:79]
    v_bfe_u32 v8, v1, 2, 2
    s_and_b32 s48, s96, 0x1800
    v_lshl_add_u32 v9, v8, 7, s48
    v_lshrrev_b32 v8, 1, v8
    v_lshl_add_u32 v9, v8, 6, v9
    v_bfe_u32 v8, v1, 4, 1
    v_lshl_add_u32 v9, v8, 5, v9
    v_and_b32 v8, 3, v1
    v_lshl_add_u32 v9, v8, 3, v9
    v_lshl_add_u32 v4, v3, 9, v9
    v_xor_b32 v5, 64, v4
    v_add_u32 v6, 0x10000, v4
    v_add_u32 v7, 0x10000, v5
    v_add_u32 v10, 0x20000, v4
    v_add_u32 v11, 0x20000, v5
    v_add_f32_e64 v64, v64, |v64|
    v_add_f32_e64 v65, v65, |v65|
    v_add_f32_e64 v66, v66, |v66|
    v_add_f32_e64 v67, v67, |v67|
    v_add_f32_e64 v68, v68, |v68|
    v_add_f32_e64 v69, v69, |v69|
    v_add_f32_e64 v70, v70, |v70|
    v_add_f32_e64 v71, v71, |v71|
    v_add_f32_e64 v72, v72, |v72|
    v_add_f32_e64 v73, v73, |v73|
    v_add_f32_e64 v74, v74, |v74|
    v_add_f32_e64 v75, v75, |v75|
    v_add_f32_e64 v76, v76, |v76|
    v_add_f32_e64 v77, v77, |v77|
    v_add_f32_e64 v78, v78, |v78|
    v_add_f32_e64 v79, v79, |v79|
    v_mul_f32 v64, v64, v64
    v_mul_f32 v65, v65, v65
    v_mul_f32 v66, v66, v66
    v_mul_f32 v67, v67, v67
    v_mul_f32 v68, v68, v68
    v_mul_f32 v69, v69, v69
    v_mul_f32 v70, v70, v70
    v_mul_f32 v71, v71, v71
    v_mul_f32 v72, v72, v72
    v_mul_f32 v73, v73, v73
    v_mul_f32 v74, v74, v74
    v_mul_f32 v75, v75, v75
    v_mul_f32 v76, v76, v76
    v_mul_f32 v77, v77, v77
    v_mul_f32 v78, v78, v78
    v_mul_f32 v79, v79, v79
    v_mul_f32 v64, v64, v126
    v_mul_f32 v65, v65, v126
    v_mul_f32 v66, v66, v126
    v_mul_f32 v67, v67, v126
    v_mul_f32 v68, v68, v126
    v_mul_f32 v69, v69, v126
    v_mul_f32 v70, v70, v126
    v_mul_f32 v71, v71, v126
    v_mul_f32 v72, v72, v126
    v_mul_f32 v73, v73, v126
    v_mul_f32 v74, v74, v126
    v_mul_f32 v75, v75, v126
    v_mul_f32 v76, v76, v126
    v_mul_f32 v77, v77, v126
    v_mul_f32 v78, v78, v126
    v_mul_f32 v79, v79, v126
    v_cvt_pk_bf16_f32 v64, v64, v65
    v_cvt_pk_bf16_f32 v65, v66, v67
    v_cvt_pk_bf16_f32 v66, v68, v69
    v_cvt_pk_bf16_f32 v67, v70, v71
    v_cvt_pk_bf16_f32 v68, v72, v73
    v_cvt_pk_bf16_f32 v69, v74, v75
    v_cvt_pk_bf16_f32 v70, v76, v77
    v_cvt_pk_bf16_f32 v71, v78, v79
    s_add_u32 s51, s51, 4096
    buffer_store_dwordx4 v[64:67], v30, s[12:15], s51 offen offset:0 sc1
    buffer_store_dwordx4 v[68:71], v30, s[12:15], s51 offen offset:1024 sc1
    s_waitcnt vmcnt(2)
    s_barrier
    v_max3_f32 v120, v32, v33, v34
    v_min3_f32 v122, v32, v33, v34
    ds_read_b64_tr_b16 v[128:129], v4 offset:0
    v_max3_f32 v120, v120, v35, v36
    v_min3_f32 v122, v122, v35, v36
    ds_read_b64_tr_b16 v[130:131], v4 offset:1024
    v_max3_f32 v120, v120, v37, v38
    ds_read_b64_tr_b16 v[132:133], v5 offset:0
    v_min3_f32 v122, v122, v37, v38
    v_max_f32 v120, v120, v39
    ds_read_b64_tr_b16 v[134:135], v5 offset:1024
    v_min_f32 v122, v122, v39
    v_max3_f32 v121, v40, v41, v42
    ds_read_b64_tr_b16 v[136:137], v4 offset:8192
    v_min3_f32 v123, v40, v41, v42
    ds_read_b64_tr_b16 v[138:139], v4 offset:9216
    v_max3_f32 v121, v121, v43, v44
    v_min3_f32 v123, v123, v43, v44
    ds_read_b64_tr_b16 v[140:141], v5 offset:8192
    v_max3_f32 v121, v121, v45, v46
    v_min3_f32 v123, v123, v45, v46
    ds_read_b64_tr_b16 v[142:143], v5 offset:9216
    v_max_f32 v121, v121, v47
    ds_read_b64_tr_b16 v[144:145], v4 offset:16384
    v_min_f32 v123, v123, v47
    v_permlane32_swap_b32 v120, v121
    ds_read_b64_tr_b16 v[146:147], v4 offset:17408
    v_permlane32_swap_b32 v122, v123
    v_max_f32 v120, v120, v121
    ds_read_b64_tr_b16 v[148:149], v5 offset:16384
    v_min_f32 v122, v122, v123
    ds_read_b64_tr_b16 v[150:151], v5 offset:17408
    v_mul_f32 v120, v120, v24
    v_mul_f32 v122, v122, v24
    ds_read_b64_tr_b16 v[152:153], v4 offset:32768
    v_mov_b32 v121, v120
    v_mov_b32 v123, v122
    ds_read_b64_tr_b16 v[154:155], v4 offset:33792
    v_permlane32_swap_b32 v120, v121
    ds_read_b64_tr_b16 v[156:157], v5 offset:32768
    v_permlane32_swap_b32 v122, v123
    v_fma_f32 v96, v32, v24, -v120
    ds_read_b64_tr_b16 v[158:159], v5 offset:33792
    v_fma_f32 v32, -v32, v24, v122
    v_fma_f32 v97, v33, v24, -v120
    ds_read_b64_tr_b16 v[160:161], v4 offset:40960
    v_fma_f32 v33, -v33, v24, v122
    ds_read_b64_tr_b16 v[162:163], v4 offset:41984
    v_fma_f32 v98, v34, v24, -v120
    v_fma_f32 v34, -v34, v24, v122
    ds_read_b64_tr_b16 v[164:165], v5 offset:40960
    v_fma_f32 v99, v35, v24, -v120
    v_fma_f32 v35, -v35, v24, v122
    ds_read_b64_tr_b16 v[166:167], v5 offset:41984
    v_fma_f32 v100, v36, v24, -v120
    ds_read_b64_tr_b16 v[168:169], v4 offset:49152
    v_fma_f32 v36, -v36, v24, v122
    v_fma_f32 v101, v37, v24, -v120
    ds_read_b64_tr_b16 v[170:171], v4 offset:50176
    v_fma_f32 v37, -v37, v24, v122
    v_fma_f32 v102, v38, v24, -v120
    ds_read_b64_tr_b16 v[172:173], v5 offset:49152
    v_fma_f32 v38, -v38, v24, v122
    ds_read_b64_tr_b16 v[174:175], v5 offset:50176
    v_fma_f32 v103, v39, v24, -v120
    v_fma_f32 v39, -v39, v24, v122
    ds_read_b64_tr_b16 v[176:177], v4 offset:57344
    v_fma_f32 v104, v40, v24, -v121
    v_fma_f32 v40, -v40, v24, v123
    ds_read_b64_tr_b16 v[178:179], v4 offset:58368
    v_fma_f32 v105, v41, v24, -v121
    ds_read_b64_tr_b16 v[180:181], v5 offset:57344
    v_fma_f32 v41, -v41, v24, v123
    v_fma_f32 v106, v42, v24, -v121
    ds_read_b64_tr_b16 v[182:183], v5 offset:58368
    v_fma_f32 v42, -v42, v24, v123
    v_fma_f32 v107, v43, v24, -v121
    ds_read_b64_tr_b16 v[184:185], v6 offset:0
    v_fma_f32 v43, -v43, v24, v123
    ds_read_b64_tr_b16 v[186:187], v6 offset:1024
    v_fma_f32 v108, v44, v24, -v121
    v_fma_f32 v44, -v44, v24, v123
    ds_read_b64_tr_b16 v[188:189], v7 offset:0
    v_fma_f32 v109, v45, v24, -v121
    v_fma_f32 v45, -v45, v24, v123
    ds_read_b64_tr_b16 v[190:191], v7 offset:1024
    v_fma_f32 v110, v46, v24, -v121
    ds_read_b64_tr_b16 v[192:193], v6 offset:8192
    v_fma_f32 v46, -v46, v24, v123
    v_fma_f32 v111, v47, v24, -v121
    ds_read_b64_tr_b16 v[194:195], v6 offset:9216
    v_fma_f32 v47, -v47, v24, v123
    v_exp_f32 v96, v96
    ds_read_b64_tr_b16 v[196:197], v7 offset:8192
    v_exp_f32 v32, v32
    ds_read_b64_tr_b16 v[198:199], v7 offset:9216
    v_exp_f32 v97, v97
    v_exp_f32 v33, v33
    ds_read_b64_tr_b16 v[200:201], v6 offset:16384
    v_exp_f32 v98, v98
    v_exp_f32 v34, v34
    ds_read_b64_tr_b16 v[202:203], v6 offset:17408
    v_exp_f32 v99, v99
    ds_read_b64_tr_b16 v[204:205], v7 offset:16384
    v_exp_f32 v35, v35
    v_exp_f32 v100, v100
    ds_read_b64_tr_b16 v[206:207], v7 offset:17408
    v_exp_f32 v36, v36
    v_exp_f32 v101, v101
    ds_read_b64_tr_b16 v[208:209], v6 offset:24576
    v_exp_f32 v37, v37
    ds_read_b64_tr_b16 v[210:211], v6 offset:25600
    v_exp_f32 v102, v102
    v_exp_f32 v38, v38
    ds_read_b64_tr_b16 v[212:213], v7 offset:24576
    v_exp_f32 v103, v103
    v_exp_f32 v39, v39
    ds_read_b64_tr_b16 v[214:215], v7 offset:25600
    v_exp_f32 v104, v104
    s_add_u32 m0, s96, 98304
    s_lshl_b32 s63, s75, 4
    buffer_load_dwordx4 v16, s[20:23], s63 offen lds
    v_exp_f32 v40, v40
    v_exp_f32 v105, v105
    s_add_u32 m0, s96, 106496
    s_lshl_b32 s63, s76, 4
    buffer_load_dwordx4 v16, s[20:23], s63 offen lds
    v_exp_f32 v41, v41
    v_exp_f32 v106, v106
    s_add_u32 m0, s96, 114688
    s_lshl_b32 s63, s77, 4
    buffer_load_dwordx4 v16, s[20:23], s63 offen lds
    v_exp_f32 v42, v42
    s_add_u32 m0, s96, 122880
    s_lshl_b32 s63, s78, 4
    buffer_load_dwordx4 v16, s[20:23], s63 offen lds
    s_waitcnt vmcnt(4)
    s_waitcnt lgkmcnt(0)
    s_barrier
    s_cmp_lg_u32 s96, 0
    s_cbranch_scc1 .Lfl29
    v_mov_b32 v60, s100
    v_mov_b32 v61, s101
    buffer_store_dwordx2 v[60:61], v25, s[12:15], s54 offen sc1
.Lfl29:
    v_mov_b32 v28, 0
    v_mov_b32 v29, 0
    ds_write_b64 v28, v[28:29] offset:0
    ds_write_b32 v28, v28 offset:8
    v_exp_f32 v107, v107
    v_exp_f32 v43, v43
    v_exp_f32 v108, v108
    v_exp_f32 v44, v44
    v_exp_f32 v109, v109
    v_exp_f32 v45, v45
    v_exp_f32 v110, v110
    v_exp_f32 v46, v46
    v_exp_f32 v111, v111
    v_exp_f32 v47, v47
    s_add_u32 m0, s96, 131072
    s_lshl_b32 s63, s79, 4
    buffer_load_dwordx4 v16, s[20:23], s63 offen lds
    v_add_f32 v124, v96, v97
    v_add_f32 v126, v32, v33
    v_add_f32 v125, v104, v105
    v_add_f32 v127, v40, v41
    v_add_f32 v124, v124, v98
    v_add_f32 v126, v126, v34
    v_add_f32 v125, v125, v106
    v_add_f32 v127, v127, v42
    v_add_f32 v124, v124, v99
    v_add_f32 v126, v126, v35
    s_add_u32 m0, s96, 139264
    s_lshl_b32 s63, s80, 4
    buffer_load_dwordx4 v16, s[20:23], s63 offen lds
    v_add_f32 v125, v125, v107
    v_add_f32 v127, v127, v43
    v_add_f32 v124, v124, v100
    v_add_f32 v126, v126, v36
    v_add_f32 v125, v125, v108
    v_add_f32 v127, v127, v44
    v_add_f32 v124, v124, v101
    v_add_f32 v126, v126, v37
    v_add_f32 v125, v125, v109
    v_add_f32 v127, v127, v45
    s_add_u32 m0, s96, 147456
    s_lshl_b32 s63, s81, 4
    buffer_load_dwordx4 v16, s[20:23], s63 offen lds
    v_add_f32 v124, v124, v102
    v_add_f32 v126, v126, v38
    v_add_f32 v125, v125, v110
    v_add_f32 v127, v127, v46
    v_add_f32 v124, v124, v103
    v_add_f32 v126, v126, v39
    v_add_f32 v125, v125, v111
    v_add_f32 v127, v127, v47
    s_nop 0
    v_permlane32_swap_b32 v124, v125
    v_permlane32_swap_b32 v126, v127
    s_add_u32 m0, s96, 155648
    s_lshl_b32 s63, s82, 4
    buffer_load_dwordx4 v16, s[20:23], s63 offen lds
    v_add_f32 v124, v124, v125
    v_add_f32 v126, v126, v127
    v_rcp_f32 v126, v126
    v_mov_b32 v125, v124
    v_mul_f32 v126, v126, v124
    v_mov_b32 v127, v126
    v_permlane32_swap_b32 v124, v125
    s_nop 0
    v_permlane32_swap_b32 v126, v127
    v_mul_f32 v32, v32, v126
    v_mul_f32 v33, v33, v126
    s_add_u32 m0, s96, 8192
    s_lshl_b32 s63, s83, 4
    buffer_load_dwordx4 v16, s[20:23], s63 offen lds
    v_mul_f32 v34, v34, v126
    v_mul_f32 v35, v35, v126
    v_mul_f32 v36, v36, v126
    v_mul_f32 v37, v37, v126
    v_mul_f32 v38, v38, v126
    v_mul_f32 v39, v39, v126
    v_mul_f32 v40, v40, v127
    v_mul_f32 v41, v41, v127
    v_mul_f32 v42, v42, v127
    v_mul_f32 v43, v43, v127
    s_add_u32 m0, s96, 16384
    s_lshl_b32 s63, s84, 4
    buffer_load_dwordx4 v16, s[20:23], s63 offen lds
    v_mul_f32 v44, v44, v127
    v_mul_f32 v45, v45, v127
    v_mul_f32 v46, v46, v127
    v_mul_f32 v47, v47, v127
    v_cvt_pk_bf16_f32 v80, v96, v97
    v_cvt_pk_bf16_f32 v81, v98, v99
    v_cvt_pk_bf16_f32 v82, v100, v101
    v_cvt_pk_bf16_f32 v83, v102, v103
    v_cvt_pk_bf16_f32 v84, v32, v33
    v_cvt_pk_bf16_f32 v85, v34, v35
    s_add_u32 m0, s96, 24576
    s_lshl_b32 s63, s85, 4
    buffer_load_dwordx4 v16, s[20:23], s63 offen lds
    v_cvt_pk_bf16_f32 v86, v36, v37
    v_cvt_pk_bf16_f32 v87, v38, v39
    v_cvt_pk_bf16_f32 v88, v104, v105
    v_cvt_pk_bf16_f32 v89, v106, v107
    v_cvt_pk_bf16_f32 v90, v108, v109
    v_cvt_pk_bf16_f32 v91, v110, v111
    v_cvt_pk_bf16_f32 v92, v40, v41
    v_cvt_pk_bf16_f32 v93, v42, v43
    v_cvt_pk_bf16_f32 v94, v44, v45
    v_cvt_pk_bf16_f32 v95, v46, v47
    s_add_u32 m0, s96, 32768
    s_lshl_b32 s63, s86, 4
    buffer_load_dwordx4 v16, s[24:27], s63 offen lds
    v_mov_b32 v112, v124
    v_mov_b32 v113, v125
    v_and_b32 v48, 15, v2
    v_lshl_add_u32 v48, v3, 5, v48
    v_lshlrev_b32 v48, 4, v48
    v_lshlrev_b32 v49, 4, v3
    v_add_u32 v49, 4096, v49
    v_cmp_gt_u32 vcc, 16, v2
    v_mov_b32 v58, 32
    v_mov_b32 v59, 0x400
    v_cndmask_b32_e64 v50, v49, v48, vcc
    v_cndmask_b32_e64 v49, v58, v59, vcc
    v_mov_b32 v58, 0x80
    v_mov_b32 v59, 0x100
    v_add_u32 v51, v50, v49
    v_cndmask_b32_e64 v48, v58, v59, vcc
    v_add_u32 v52, v51, v49
    v_add_u32 v53, v52, v49
    v_add_u32 v54, v50, v48
    v_add_u32 v55, v51, v48
    v_add_u32 v56, v52, v48
    v_add_u32 v57, v53, v48
    v_mov_b32 v124, 0x358637bd
    s_add_u32 m0, s96, 40960
    s_lshl_b32 s63, s87, 4
    buffer_load_dwordx4 v16, s[24:27], s63 offen lds
    s_add_u32 m0, s96, 49152
    s_lshl_b32 s63, s88, 4
    buffer_load_dwordx4 v16, s[24:27], s63 offen lds
    s_add_u32 m0, s96, 57344
    s_lshl_b32 s63, s89, 4
    buffer_load_dwordx4 v16, s[24:27], s63 offen lds
    s_add_u32 m0, s96, 65536
    s_lshl_b32 s63, s90, 4
    buffer_load_dwordx4 v16, s[24:27], s63 offen lds
    s_add_u32 m0, s96, 73728
    s_lshl_b32 s63, s91, 4
    buffer_load_dwordx4 v16, s[24:27], s63 offen lds
    s_add_u32 m0, s96, 81920
    s_lshl_b32 s63, s92, 4
    buffer_load_dwordx4 v16, s[24:27], s63 offen lds
    s_add_u32 m0, s96, 90112
    s_lshl_b32 s63, s93, 4
    buffer_load_dwordx4 v16, s[24:27], s63 offen lds
    s_load_dwordx2 s[28:29], s[0:1], 64
    s_load_dwordx2 s[8:9], s[0:1], 72
    v_and_b32 v20, 7, v1
    v_lshrrev_b32 v24, 3, v1
    s_lshl_b32 s62, s96, 3
    v_lshlrev_b32 v27, 1, v20
    v_lshlrev_b32 v20, 4, v20
    v_lshl_add_u32 v17, v24, 10, v20
    s_add_u32 s57, s57, s62
    v_xor_b32 v26, v27, v24
    v_xor_b32 v27, 1, v26
    v_lshl_add_u32 v24, v24, 8, s97
    v_add_u32 v24, 98304, v24
    v_lshl_add_u32 v26, v26, 4, v24
    v_lshl_add_u32 v27, v27, 4, v24
    v_and_b32 v24, 7, v2
    v_xor_b32 v24, v24, v3
    v_lshl_add_u32 v21, v2, 8, s62
    v_add_u32 v21, 98304, v21
    v_xor_b32 v12, 0, v24
    v_lshl_add_u32 v12, v12, 4, v21
    v_xor_b32 v13, 2, v24
    v_lshl_add_u32 v13, v13, 4, v21
    v_xor_b32 v14, 4, v24
    v_lshl_add_u32 v14, v14, 4, v21
    v_xor_b32 v15, 6, v24
    v_lshl_add_u32 v15, v15, 4, v21
    s_mov_b32 s30, 1024
    s_mov_b32 s10, 2097152
    s_waitcnt lgkmcnt(0)
    s_cmp_lg_u32 s96, 0
    s_cbranch_scc1 .Lpd30
    v_and_b32 v62, 15, v1
    v_lshlrev_b32 v62, 3, v62
    s_mov_b32 s3, 0
.Lpl31:
    buffer_load_dwordx2 v[60:61], v62, s[12:15], s56 offen sc1
    s_add_u32 s3, s3, 1
    s_waitcnt vmcnt(0)
    v_cmp_eq_u64 vcc, s[100:101], v[60:61]
    s_nop 0
    s_cmp_eq_u64 vcc, exec
    s_cbranch_scc1 .Lpd30
    s_cmp_lt_u32 s3, 20000
    s_cbranch_scc1 .Lpl31
.Lpd30:
    s_barrier
    buffer_load_dwordx4 v[216:219], v50, s[12:15], s53 offen sc1
    buffer_load_dwordx4 v[220:223], v51, s[12:15], s53 offen sc1
    buffer_load_dwordx4 v[224:227], v52, s[12:15], s53 offen sc1
    buffer_load_dwordx4 v[228:231], v53, s[12:15], s53 offen sc1
    buffer_load_dwordx4 v[232:235], v54, s[12:15], s53 offen sc1
    buffer_load_dwordx4 v[236:239], v55, s[12:15], s53 offen sc1
    buffer_load_dwordx4 v[240:243], v56, s[12:15], s53 offen sc1
    buffer_load_dwordx4 v[244:247], v57, s[12:15], s53 offen sc1
    s_waitcnt vmcnt(4)
    v_cvt_pk_bf16_f32 v96, v216, v217
    v_cvt_pk_bf16_f32 v97, v218, v219
    v_cvt_pk_bf16_f32 v98, v220, v221
    v_cvt_pk_bf16_f32 v99, v222, v223
    v_cvt_pk_bf16_f32 v100, v224, v225
    v_cvt_pk_bf16_f32 v101, v226, v227
    v_cvt_pk_bf16_f32 v102, v228, v229
    v_cvt_pk_bf16_f32 v103, v230, v231
    v_mfma_f32_32x32x16_bf16 v[32:47], v[96:99], v[80:83], 0
    s_nop 0
    v_mfma_f32_32x32x16_bf16 v[32:47], v[100:103], v[84:87], v[32:47]
    s_waitcnt vmcnt(0)
    v_cvt_pk_bf16_f32 v104, v232, v233
    v_cvt_pk_bf16_f32 v105, v234, v235
    v_cvt_pk_bf16_f32 v106, v236, v237
    v_cvt_pk_bf16_f32 v107, v238, v239
    v_cvt_pk_bf16_f32 v108, v240, v241
    v_cvt_pk_bf16_f32 v109, v242, v243
    v_cvt_pk_bf16_f32 v110, v244, v245
    v_cvt_pk_bf16_f32 v111, v246, v247
    v_mfma_f32_32x32x16_bf16 v[64:79], v[104:107], v[88:91], 0
    s_nop 0
    v_mfma_f32_32x32x16_bf16 v[64:79], v[108:111], v[92:95], v[64:79]
    v_fma_f32 v40, v112, v124, v40
    v_rcp_f32 v40, v40
    s_nop 0
    v_mul_f32 v32, v32, v40
    v_mul_f32 v33, v33, v40
    v_mul_f32 v34, v34, v40
    v_mul_f32 v35, v35, v40
    v_mul_f32 v36, v36, v40
    v_mul_f32 v37, v37, v40
    v_mul_f32 v38, v38, v40
    v_mul_f32 v39, v39, v40
    v_cvt_pk_bf16_f32 v48, v32, v33
    v_cvt_pk_bf16_f32 v49, v34, v35
    v_cvt_pk_bf16_f32 v50, v36, v37
    v_cvt_pk_bf16_f32 v51, v38, v39
    buffer_store_dwordx4 v[48:51], v30, s[12:15], s60 offen offset:0 sc1
    v_fma_f32 v72, v113, v124, v72
    v_rcp_f32 v72, v72
    s_nop 0
    v_mul_f32 v64, v64, v72
    v_mul_f32 v65, v65, v72
    v_mul_f32 v66, v66, v72
    v_mul_f32 v67, v67, v72
    v_mul_f32 v68, v68, v72
    v_mul_f32 v69, v69, v72
    v_mul_f32 v70, v70, v72
    v_mul_f32 v71, v71, v72
    v_cvt_pk_bf16_f32 v52, v64, v65
    v_cvt_pk_bf16_f32 v53, v66, v67
    v_cvt_pk_bf16_f32 v54, v68, v69
    v_cvt_pk_bf16_f32 v55, v70, v71
    buffer_store_dwordx4 v[52:55], v30, s[12:15], s60 offen offset:1024 sc1
    v_mov_b32 v112, 0
    s_waitcnt lgkmcnt(0)
    s_cmp_lg_u32 s96, 0
    s_cbranch_scc1 .Lpd32
    v_and_b32 v118, 15, v1
    v_lshlrev_b32 v118, 3, v118
    s_mov_b32 s3, 0
.Lpl33:
    buffer_load_dwordx2 v[116:117], v118, s[12:15], s59 offen sc1
    s_add_u32 s3, s3, 1
    s_waitcnt vmcnt(0)
    v_cmp_eq_u64 vcc, s[100:101], v[116:117]
    s_nop 0
    s_cmp_eq_u64 vcc, exec
    s_cbranch_scc1 .Lpd32
    s_cmp_lt_u32 s3, 20000
    s_cbranch_scc1 .Lpl33
.Lpd32:
    s_barrier
    s_add_u32 s48, s64, s58
    buffer_load_dwordx4 v[216:219], v30, s[12:15], s48 offen sc1
    s_add_u32 s48, s65, s58
    buffer_load_dwordx4 v[220:223], v30, s[12:15], s48 offen sc1
    s_add_u32 s48, s66, s58
    buffer_load_dwordx4 v[224:227], v30, s[12:15], s48 offen sc1
    s_add_u32 s48, s67, s58
    buffer_load_dwordx4 v[228:231], v30, s[12:15], s48 offen sc1
    s_add_u32 s48, s68, s58
    buffer_load_dwordx4 v[232:235], v30, s[12:15], s48 offen sc1
    s_waitcnt vmcnt(4)
    v_mfma_f32_32x32x16_bf16 v[32:47], v[128:131], v[216:219], 0
    v_mfma_f32_32x32x16_bf16 v[48:63], v[132:135], v[216:219], 0
    s_add_u32 s48, s69, s58
    buffer_load_dwordx4 v[236:239], v30, s[12:15], s48 offen sc1
    s_waitcnt vmcnt(4)
    v_mfma_f32_32x32x16_bf16 v[32:47], v[136:139], v[220:223], v[32:47]
    v_mfma_f32_32x32x16_bf16 v[48:63], v[140:143], v[220:223], v[48:63]
    v_mov_b32 v22, 8
    v_mov_b32 v23, 1
    s_mov_b64 exec, 1
    ds_add_rtn_u32 v22, v22, v23
    s_mov_b64 exec, -1
    s_add_u32 s48, s70, s58
    buffer_load_dwordx4 v[240:243], v30, s[12:15], s48 offen sc1
    s_waitcnt vmcnt(4)
    v_mfma_f32_32x32x16_bf16 v[32:47], v[144:147], v[224:227], v[32:47]
    v_mfma_f32_32x32x16_bf16 v[48:63], v[148:151], v[224:227], v[48:63]
    s_waitcnt lgkmcnt(0)
    v_readfirstlane_b32 s48, v22
    s_nop 0
    s_cmp_lg_u32 s48, 7
    s_cbranch_scc1 .Lkf34
    v_mov_b32 v116, s100
    v_mov_b32 v117, s101
    buffer_store_dwordx2 v[116:117], v25, s[12:15], s55 offen sc1
.Lkf34:
    s_add_u32 s48, s71, s58
    buffer_load_dwordx4 v[244:247], v30, s[12:15], s48 offen sc1
    s_waitcnt vmcnt(4)
    v_mfma_f32_32x32x16_bf16 v[32:47], v[152:155], v[228:231], v[32:47]
    v_mfma_f32_32x32x16_bf16 v[48:63], v[156:159], v[228:231], v[48:63]
    s_add_u32 s48, s72, s58
    buffer_load_dwordx4 v[248:251], v30, s[12:15], s48 offen sc1
    s_waitcnt vmcnt(4)
    v_mfma_f32_32x32x16_bf16 v[32:47], v[160:163], v[232:235], v[32:47]
    v_mfma_f32_32x32x16_bf16 v[48:63], v[164:167], v[232:235], v[48:63]
    s_add_u32 s48, s73, s58
    buffer_load_dwordx4 v[252:255], v30, s[12:15], s48 offen sc1
    s_waitcnt vmcnt(4)
    v_mfma_f32_32x32x16_bf16 v[32:47], v[168:171], v[236:239], v[32:47]
    v_mfma_f32_32x32x16_bf16 v[48:63], v[172:175], v[236:239], v[48:63]
    s_add_u32 s48, s74, s58
    buffer_load_dwordx4 v[216:219], v30, s[12:15], s48 offen sc1
    s_waitcnt vmcnt(4)
    v_mfma_f32_32x32x16_bf16 v[32:47], v[176:179], v[240:243], v[32:47]
    v_mfma_f32_32x32x16_bf16 v[48:63], v[180:183], v[240:243], v[48:63]
    s_add_u32 s48, s75, s58
    buffer_load_dwordx4 v[220:223], v30, s[12:15], s48 offen sc1
    s_waitcnt vmcnt(4)
    v_mfma_f32_32x32x16_bf16 v[32:47], v[184:187], v[244:247], v[32:47]
    v_mfma_f32_32x32x16_bf16 v[48:63], v[188:191], v[244:247], v[48:63]
    s_add_u32 s48, s76, s58
    buffer_load_dwordx4 v[224:227], v30, s[12:15], s48 offen sc1
    s_waitcnt vmcnt(4)
    v_mfma_f32_32x32x16_bf16 v[32:47], v[192:195], v[248:251], v[32:47]
    v_mfma_f32_32x32x16_bf16 v[48:63], v[196:199], v[248:251], v[48:63]
    s_barrier
    ds_read_b64_tr_b16 v[88:89], v6 offset:32768
    ds_read_b64_tr_b16 v[90:91], v6 offset:33792
    ds_read_b64_tr_b16 v[92:93], v7 offset:32768
    ds_read_b64_tr_b16 v[94:95], v7 offset:33792
    ds_read_b64_tr_b16 v[64:65], v6 offset:40960
    ds_read_b64_tr_b16 v[66:67], v6 offset:41984
    ds_read_b64_tr_b16 v[68:69], v7 offset:40960
    ds_read_b64_tr_b16 v[70:71], v7 offset:41984
    ds_read_b64_tr_b16 v[72:73], v6 offset:49152
    ds_read_b64_tr_b16 v[74:75], v6 offset:50176
    ds_read_b64_tr_b16 v[76:77], v7 offset:49152
    ds_read_b64_tr_b16 v[78:79], v7 offset:50176
    s_add_u32 s48, s77, s58
    buffer_load_dwordx4 v[228:231], v30, s[12:15], s48 offen sc1
    s_waitcnt vmcnt(4)
    v_mfma_f32_32x32x16_bf16 v[32:47], v[200:203], v[252:255], v[32:47]
    v_mfma_f32_32x32x16_bf16 v[48:63], v[204:207], v[252:255], v[48:63]
    s_add_u32 s48, s78, s58
    buffer_load_dwordx4 v[232:235], v30, s[12:15], s48 offen sc1
    s_waitcnt vmcnt(4)
    v_mfma_f32_32x32x16_bf16 v[32:47], v[208:211], v[216:219], v[32:47]
    v_mfma_f32_32x32x16_bf16 v[48:63], v[212:215], v[216:219], v[48:63]
    s_add_u32 s48, s79, s58
    buffer_load_dwordx4 v[236:239], v30, s[12:15], s48 offen sc1
    v_and_b32 v118, 7, v1
    s_cmp_eq_u32 s96, 0
    v_lshlrev_b32 v118, 3, v118
    s_cselect_b32 s48, s59, 0x20000000
    v_add_u32 v118, 4096, v118
    buffer_load_dwordx2 v[116:117], v118, s[12:15], s48 offen sc1
    s_waitcnt vmcnt(5)
    s_waitcnt lgkmcnt(8)
    v_mfma_f32_32x32x16_bf16 v[32:47], v[88:91], v[220:223], v[32:47]
    v_mfma_f32_32x32x16_bf16 v[48:63], v[92:95], v[220:223], v[48:63]
    ds_read_b64_tr_b16 v[80:81], v6 offset:57344
    ds_read_b64_tr_b16 v[82:83], v6 offset:58368
    ds_read_b64_tr_b16 v[84:85], v7 offset:57344
    ds_read_b64_tr_b16 v[86:87], v7 offset:58368
    s_add_u32 s48, s80, s58
    buffer_load_dwordx4 v[240:243], v30, s[12:15], s48 offen sc1
    s_waitcnt vmcnt(5)
    s_waitcnt lgkmcnt(8)
    v_mfma_f32_32x32x16_bf16 v[32:47], v[64:67], v[224:227], v[32:47]
    v_mfma_f32_32x32x16_bf16 v[48:63], v[68:71], v[224:227], v[48:63]
    ds_read_b64_tr_b16 v[88:89], v10 offset:0
    ds_read_b64_tr_b16 v[90:91], v10 offset:1024
    ds_read_b64_tr_b16 v[92:93], v11 offset:0
    ds_read_b64_tr_b16 v[94:95], v11 offset:1024
    s_add_u32 s48, s81, s58
    buffer_load_dwordx4 v[244:247], v30, s[12:15], s48 offen sc1
    s_waitcnt vmcnt(5)
    s_waitcnt lgkmcnt(8)
    v_mfma_f32_32x32x16_bf16 v[32:47], v[72:75], v[228:231], v[32:47]
    v_mfma_f32_32x32x16_bf16 v[48:63], v[76:79], v[228:231], v[48:63]
    ds_read_b64_tr_b16 v[64:65], v10 offset:8192
    ds_read_b64_tr_b16 v[66:67], v10 offset:9216
    ds_read_b64_tr_b16 v[68:69], v11 offset:8192
    ds_read_b64_tr_b16 v[70:71], v11 offset:9216
    s_add_u32 s48, s82, s58
    buffer_load_dwordx4 v[248:251], v30, s[12:15], s48 offen sc1
    s_waitcnt vmcnt(5)
    s_waitcnt lgkmcnt(8)
    v_mfma_f32_32x32x16_bf16 v[32:47], v[80:83], v[232:235], v[32:47]
    v_mfma_f32_32x32x16_bf16 v[48:63], v[84:87], v[232:235], v[48:63]
    ds_read_b64_tr_b16 v[72:73], v10 offset:16384
    ds_read_b64_tr_b16 v[74:75], v10 offset:17408
    ds_read_b64_tr_b16 v[76:77], v11 offset:16384
    ds_read_b64_tr_b16 v[78:79], v11 offset:17408
    s_add_u32 s48, s83, s58
    buffer_load_dwordx4 v[252:255], v30, s[12:15], s48 offen sc1
    s_waitcnt vmcnt(4)
    v_cmp_eq_u64 vcc, s[100:101], v[116:117]
    s_nop 0
    s_cmp_eq_u64 vcc, exec
    s_cbranch_scc0 .Leo35
    ds_write_b64 v112, v[116:117]
.Leo35:
    s_waitcnt lgkmcnt(8)
    v_mfma_f32_32x32x16_bf16 v[32:47], v[88:91], v[236:239], v[32:47]
    v_mfma_f32_32x32x16_bf16 v[48:63], v[92:95], v[236:239], v[48:63]
    ds_read_b64_tr_b16 v[80:81], v10 offset:24576
    ds_read_b64_tr_b16 v[82:83], v10 offset:25600
    ds_read_b64_tr_b16 v[84:85], v11 offset:24576
    ds_read_b64_tr_b16 v[86:87], v11 offset:25600
    s_add_u32 s48, s84, s58
    buffer_load_dwordx4 v[216:219], v30, s[12:15], s48 offen sc1
    s_waitcnt vmcnt(4)
    s_waitcnt lgkmcnt(8)
    v_mfma_f32_32x32x16_bf16 v[32:47], v[64:67], v[240:243], v[32:47]
    v_mfma_f32_32x32x16_bf16 v[48:63], v[68:71], v[240:243], v[48:63]
    ds_read_b64_tr_b16 v[88:89], v4 offset:8192
    ds_read_b64_tr_b16 v[90:91], v4 offset:9216
    ds_read_b64_tr_b16 v[92:93], v5 offset:8192
    ds_read_b64_tr_b16 v[94:95], v5 offset:9216
    s_add_u32 s48, s85, s58
    buffer_load_dwordx4 v[220:223], v30, s[12:15], s48 offen sc1
    ds_read_b64 v[114:115], v112
    s_waitcnt vmcnt(4)
    s_waitcnt lgkmcnt(9)
    v_mfma_f32_32x32x16_bf16 v[32:47], v[72:75], v[244:247], v[32:47]
    v_mfma_f32_32x32x16_bf16 v[48:63], v[76:79], v[244:247], v[48:63]
    ds_read_b64_tr_b16 v[64:65], v4 offset:16384
    ds_read_b64_tr_b16 v[66:67], v4 offset:17408
    ds_read_b64_tr_b16 v[68:69], v5 offset:16384
    ds_read_b64_tr_b16 v[70:71], v5 offset:17408
    buffer_load_dwordx4 v[120:123], v17, s[4:7], s57 offen
    buffer_load_dwordx4 v[124:127], v20, s[28:31], s61 offen
    s_waitcnt lgkmcnt(4)
    v_cmp_eq_u64 vcc, s[100:101], v[114:115]
    s_nop 0
    s_cmp_eq_u64 vcc, exec
    s_cbranch_scc0 .Llate36
    s_add_u32 s48, s86, s58
    buffer_load_dwordx4 v[128:131], v30, s[12:15], s48 offen sc1
    s_add_u32 s48, s87, s58
    buffer_load_dwordx4 v[132:135], v30, s[12:15], s48 offen sc1
    s_add_u32 s48, s88, s58
    buffer_load_dwordx4 v[136:139], v30, s[12:15], s48 offen sc1
    s_add_u32 s48, s89, s58
    buffer_load_dwordx4 v[140:143], v30, s[12:15], s48 offen sc1
    s_add_u32 s48, s90, s58
    buffer_load_dwordx4 v[144:147], v30, s[12:15], s48 offen sc1
    s_add_u32 s48, s91, s58
    buffer_load_dwordx4 v[148:151], v30, s[12:15], s48 offen sc1
    s_add_u32 s48, s92, s58
    buffer_load_dwordx4 v[152:155], v30, s[12:15], s48 offen sc1
    s_add_u32 s48, s93, s58
    buffer_load_dwordx4 v[156:159], v30, s[12:15], s48 offen sc1
    s_waitcnt vmcnt(13)
    v_mfma_f32_32x32x16_bf16 v[32:47], v[80:83], v[248:251], v[32:47]
    v_mfma_f32_32x32x16_bf16 v[48:63], v[84:87], v[248:251], v[48:63]
    ds_read_b64_tr_b16 v[72:73], v4 offset:24576
    ds_read_b64_tr_b16 v[74:75], v4 offset:25600
    ds_read_b64_tr_b16 v[76:77], v5 offset:24576
    ds_read_b64_tr_b16 v[78:79], v5 offset:25600
    s_waitcnt vmcnt(12)
    v_mfma_f32_32x32x16_bf16 v[32:47], v[88:91], v[252:255], v[32:47]
    v_mfma_f32_32x32x16_bf16 v[48:63], v[92:95], v[252:255], v[48:63]
    ds_read_b64_tr_b16 v[80:81], v4 offset:32768
    ds_read_b64_tr_b16 v[82:83], v4 offset:33792
    ds_read_b64_tr_b16 v[84:85], v5 offset:32768
    ds_read_b64_tr_b16 v[86:87], v5 offset:33792
    s_barrier
    s_waitcnt vmcnt(11)
    s_waitcnt lgkmcnt(8)
    v_mfma_f32_32x32x16_bf16 v[32:47], v[64:67], v[216:219], v[32:47]
    v_mfma_f32_32x32x16_bf16 v[48:63], v[68:71], v[216:219], v[48:63]
    ds_read_b64_tr_b16 v[88:89], v4 offset:40960
    ds_read_b64_tr_b16 v[90:91], v4 offset:41984
    ds_read_b64_tr_b16 v[92:93], v5 offset:40960
    ds_read_b64_tr_b16 v[94:95], v5 offset:41984
    s_waitcnt vmcnt(10)
    s_waitcnt lgkmcnt(8)
    v_mfma_f32_32x32x16_bf16 v[32:47], v[72:75], v[220:223], v[32:47]
    v_mfma_f32_32x32x16_bf16 v[48:63], v[76:79], v[220:223], v[48:63]
    ds_read_b64_tr_b16 v[64:65], v4 offset:49152
    ds_read_b64_tr_b16 v[66:67], v4 offset:50176
    ds_read_b64_tr_b16 v[68:69], v5 offset:49152
    ds_read_b64_tr_b16 v[70:71], v5 offset:50176
    s_waitcnt vmcnt(7)
    s_waitcnt lgkmcnt(8)
    v_mfma_f32_32x32x16_bf16 v[32:47], v[80:83], v[128:131], v[32:47]
    v_mfma_f32_32x32x16_bf16 v[48:63], v[84:87], v[128:131], v[48:63]
    ds_read_b64_tr_b16 v[72:73], v4 offset:57344
    ds_read_b64_tr_b16 v[74:75], v4 offset:58368
    ds_read_b64_tr_b16 v[76:77], v5 offset:57344
    ds_read_b64_tr_b16 v[78:79], v5 offset:58368
    s_waitcnt vmcnt(6)
    s_waitcnt lgkmcnt(8)
    v_mfma_f32_32x32x16_bf16 v[32:47], v[88:91], v[132:135], v[32:47]
    v_mfma_f32_32x32x16_bf16 v[48:63], v[92:95], v[132:135], v[48:63]
    ds_read_b64_tr_b16 v[80:81], v6 offset:0
    ds_read_b64_tr_b16 v[82:83], v6 offset:1024
    ds_read_b64_tr_b16 v[84:85], v7 offset:0
    ds_read_b64_tr_b16 v[86:87], v7 offset:1024
    s_waitcnt vmcnt(5)
    s_waitcnt lgkmcnt(8)
    v_mfma_f32_32x32x16_bf16 v[32:47], v[64:67], v[136:139], v[32:47]
    v_mfma_f32_32x32x16_bf16 v[48:63], v[68:71], v[136:139], v[48:63]
    ds_read_b64_tr_b16 v[88:89], v6 offset:8192
    ds_read_b64_tr_b16 v[90:91], v6 offset:9216
    ds_read_b64_tr_b16 v[92:93], v7 offset:8192
    ds_read_b64_tr_b16 v[94:95], v7 offset:9216
    s_waitcnt vmcnt(4)
    s_waitcnt lgkmcnt(8)
    v_mfma_f32_32x32x16_bf16 v[32:47], v[72:75], v[140:143], v[32:47]
    v_mfma_f32_32x32x16_bf16 v[48:63], v[76:79], v[140:143], v[48:63]
    ds_read_b64_tr_b16 v[64:65], v6 offset:16384
    ds_read_b64_tr_b16 v[66:67], v6 offset:17408
    ds_read_b64_tr_b16 v[68:69], v7 offset:16384
    ds_read_b64_tr_b16 v[70:71], v7 offset:17408
    s_waitcnt vmcnt(3)
    s_waitcnt lgkmcnt(8)
    v_mfma_f32_32x32x16_bf16 v[32:47], v[80:83], v[144:147], v[32:47]
    v_mfma_f32_32x32x16_bf16 v[48:63], v[84:87], v[144:147], v[48:63]
    ds_read_b64_tr_b16 v[72:73], v6 offset:24576
    ds_read_b64_tr_b16 v[74:75], v6 offset:25600
    ds_read_b64_tr_b16 v[76:77], v7 offset:24576
    ds_read_b64_tr_b16 v[78:79], v7 offset:25600
    s_waitcnt vmcnt(2)
    s_waitcnt lgkmcnt(8)
    v_mfma_f32_32x32x16_bf16 v[32:47], v[88:91], v[148:151], v[32:47]
    v_mfma_f32_32x32x16_bf16 v[48:63], v[92:95], v[148:151], v[48:63]
    s_waitcnt vmcnt(1)
    s_waitcnt lgkmcnt(4)
    v_mfma_f32_32x32x16_bf16 v[32:47], v[64:67], v[152:155], v[32:47]
    v_mfma_f32_32x32x16_bf16 v[48:63], v[68:71], v[152:155], v[48:63]
    s_waitcnt vmcnt(0)
    s_waitcnt lgkmcnt(0)
    v_mfma_f32_32x32x16_bf16 v[32:47], v[72:75], v[156:159], v[32:47]
    v_mfma_f32_32x32x16_bf16 v[48:63], v[76:79], v[156:159], v[48:63]
    s_branch .Ljoin37
.Llate36:
    s_waitcnt vmcnt(5)
    v_mfma_f32_32x32x16_bf16 v[32:47], v[80:83], v[248:251], v[32:47]
    v_mfma_f32_32x32x16_bf16 v[48:63], v[84:87], v[248:251], v[48:63]
    ds_read_b64_tr_b16 v[72:73], v4 offset:24576
    ds_read_b64_tr_b16 v[74:75], v4 offset:25600
    ds_read_b64_tr_b16 v[76:77], v5 offset:24576
    ds_read_b64_tr_b16 v[78:79], v5 offset:25600
    s_waitcnt vmcnt(4)
    v_mfma_f32_32x32x16_bf16 v[32:47], v[88:91], v[252:255], v[32:47]
    v_mfma_f32_32x32x16_bf16 v[48:63], v[92:95], v[252:255], v[48:63]
    ds_read_b64_tr_b16 v[80:81], v4 offset:32768
    ds_read_b64_tr_b16 v[82:83], v4 offset:33792
    ds_read_b64_tr_b16 v[84:85], v5 offset:32768
    ds_read_b64_tr_b16 v[86:87], v5 offset:33792
    s_barrier
    s_waitcnt vmcnt(3)
    s_waitcnt lgkmcnt(8)
    v_mfma_f32_32x32x16_bf16 v[32:47], v[64:67], v[216:219], v[32:47]
    v_mfma_f32_32x32x16_bf16 v[48:63], v[68:71], v[216:219], v[48:63]
    ds_read_b64_tr_b16 v[88:89], v4 offset:40960
    ds_read_b64_tr_b16 v[90:91], v4 offset:41984
    ds_read_b64_tr_b16 v[92:93], v5 offset:40960
    ds_read_b64_tr_b16 v[94:95], v5 offset:41984
    s_waitcnt vmcnt(2)
    s_waitcnt lgkmcnt(8)
    v_mfma_f32_32x32x16_bf16 v[32:47], v[72:75], v[220:223], v[32:47]
    v_mfma_f32_32x32x16_bf16 v[48:63], v[76:79], v[220:223], v[48:63]
    ds_read_b64_tr_b16 v[64:65], v4 offset:49152
    ds_read_b64_tr_b16 v[66:67], v4 offset:50176
    ds_read_b64_tr_b16 v[68:69], v5 offset:49152
    ds_read_b64_tr_b16 v[70:71], v5 offset:50176
    s_cmp_lg_u32 s96, 0
    s_mov_b32 s3, 0
    s_cbranch_scc1 .Lw39
    v_and_b32 v118, 7, v1
    v_lshlrev_b32 v118, 3, v118
    s_mov_b32 s3, 0
    v_add_u32 v118, 4096, v118
.Lpl41:
    buffer_load_dwordx2 v[116:117], v118, s[12:15], s59 offen sc1
    s_add_u32 s3, s3, 1
    s_waitcnt vmcnt(0)
    v_cmp_eq_u64 vcc, s[100:101], v[116:117]
    s_nop 0
    s_cmp_eq_u64 vcc, exec
    s_cbranch_scc1 .Lset40
    s_cmp_lt_u32 s3, 20000
    s_cbranch_scc1 .Lpl41
.Lset40:
    v_mov_b32 v116, s100
    v_mov_b32 v117, s101
    ds_write_b64 v112, v[116:117]
    s_branch .Lgo38
.Lw39:
    ds_read_b64 v[114:115], v112
    s_add_u32 s3, s3, 1
    s_waitcnt lgkmcnt(0)
    v_cmp_eq_u64 vcc, s[100:101], v[114:115]
    s_nop 0
    s_cmp_eq_u64 vcc, exec
    s_cbranch_scc1 .Lgo38
    s_sleep 1
    s_cmp_lt_u32 s3, 400000
    s_cbranch_scc1 .Lw39
.Lgo38:
    s_add_u32 s48, s86, s58
    buffer_load_dwordx4 v[128:131], v30, s[12:15], s48 offen sc1
    s_add_u32 s48, s87, s58
    buffer_load_dwordx4 v[132:135], v30, s[12:15], s48 offen sc1
    s_add_u32 s48, s88, s58
    buffer_load_dwordx4 v[136:139], v30, s[12:15], s48 offen sc1
    s_add_u32 s48, s89, s58
    buffer_load_dwordx4 v[140:143], v30, s[12:15], s48 offen sc1
    s_add_u32 s48, s90, s58
    buffer_load_dwordx4 v[144:147], v30, s[12:15], s48 offen sc1
    s_add_u32 s48, s91, s58
    buffer_load_dwordx4 v[148:151], v30, s[12:15], s48 offen sc1
    s_add_u32 s48, s92, s58
    buffer_load_dwordx4 v[152:155], v30, s[12:15], s48 offen sc1
    s_add_u32 s48, s93, s58
    buffer_load_dwordx4 v[156:159], v30, s[12:15], s48 offen sc1
    s_waitcnt vmcnt(7)
    s_waitcnt lgkmcnt(8)
    v_mfma_f32_32x32x16_bf16 v[32:47], v[80:83], v[128:131], v[32:47]
    v_mfma_f32_32x32x16_bf16 v[48:63], v[84:87], v[128:131], v[48:63]
    ds_read_b64_tr_b16 v[72:73], v4 offset:57344
    ds_read_b64_tr_b16 v[74:75], v4 offset:58368
    ds_read_b64_tr_b16 v[76:77], v5 offset:57344
    ds_read_b64_tr_b16 v[78:79], v5 offset:58368
    s_waitcnt vmcnt(6)
    s_waitcnt lgkmcnt(8)
    v_mfma_f32_32x32x16_bf16 v[32:47], v[88:91], v[132:135], v[32:47]
    v_mfma_f32_32x32x16_bf16 v[48:63], v[92:95], v[132:135], v[48:63]
    ds_read_b64_tr_b16 v[80:81], v6 offset:0
    ds_read_b64_tr_b16 v[82:83], v6 offset:1024
    ds_read_b64_tr_b16 v[84:85], v7 offset:0
    ds_read_b64_tr_b16 v[86:87], v7 offset:1024
    s_waitcnt vmcnt(5)
    s_waitcnt lgkmcnt(8)
    v_mfma_f32_32x32x16_bf16 v[32:47], v[64:67], v[136:139], v[32:47]
    v_mfma_f32_32x32x16_bf16 v[48:63], v[68:71], v[136:139], v[48:63]
    ds_read_b64_tr_b16 v[88:89], v6 offset:8192
    ds_read_b64_tr_b16 v[90:91], v6 offset:9216
    ds_read_b64_tr_b16 v[92:93], v7 offset:8192
    ds_read_b64_tr_b16 v[94:95], v7 offset:9216
    s_waitcnt vmcnt(4)
    s_waitcnt lgkmcnt(8)
    v_mfma_f32_32x32x16_bf16 v[32:47], v[72:75], v[140:143], v[32:47]
    v_mfma_f32_32x32x16_bf16 v[48:63], v[76:79], v[140:143], v[48:63]
    ds_read_b64_tr_b16 v[64:65], v6 offset:16384
    ds_read_b64_tr_b16 v[66:67], v6 offset:17408
    ds_read_b64_tr_b16 v[68:69], v7 offset:16384
    ds_read_b64_tr_b16 v[70:71], v7 offset:17408
    s_waitcnt vmcnt(3)
    s_waitcnt lgkmcnt(8)
    v_mfma_f32_32x32x16_bf16 v[32:47], v[80:83], v[144:147], v[32:47]
    v_mfma_f32_32x32x16_bf16 v[48:63], v[84:87], v[144:147], v[48:63]
    ds_read_b64_tr_b16 v[72:73], v6 offset:24576
    ds_read_b64_tr_b16 v[74:75], v6 offset:25600
    ds_read_b64_tr_b16 v[76:77], v7 offset:24576
    ds_read_b64_tr_b16 v[78:79], v7 offset:25600
    s_waitcnt vmcnt(2)
    s_waitcnt lgkmcnt(8)
    v_mfma_f32_32x32x16_bf16 v[32:47], v[88:91], v[148:151], v[32:47]
    v_mfma_f32_32x32x16_bf16 v[48:63], v[92:95], v[148:151], v[48:63]
    s_waitcnt vmcnt(1)
    s_waitcnt lgkmcnt(4)
    v_mfma_f32_32x32x16_bf16 v[32:47], v[64:67], v[152:155], v[32:47]
    v_mfma_f32_32x32x16_bf16 v[48:63], v[68:71], v[152:155], v[48:63]
    s_waitcnt vmcnt(0)
    s_waitcnt lgkmcnt(0)
    v_mfma_f32_32x32x16_bf16 v[32:47], v[72:75], v[156:159], v[32:47]
    v_mfma_f32_32x32x16_bf16 v[48:63], v[76:79], v[156:159], v[48:63]
.Ljoin37:
    s_nop 3
    v_lshlrev_b32 v64, 16, v120
    v_and_b32 v65, 0xffff0000, v120
    v_lshlrev_b32 v66, 16, v121
    v_and_b32 v67, 0xffff0000, v121
    v_lshlrev_b32 v68, 16, v122
    v_and_b32 v69, 0xffff0000, v122
    v_lshlrev_b32 v70, 16, v123
    v_and_b32 v71, 0xffff0000, v123
    s_nop 1
    ds_write_b128 v12, v[32:35] offset:0
    ds_write_b128 v13, v[36:39] offset:0
    ds_write_b128 v14, v[40:43] offset:0
    ds_write_b128 v15, v[44:47] offset:0
    ds_write_b128 v12, v[48:51] offset:128
    ds_write_b128 v13, v[52:55] offset:128
    ds_write_b128 v14, v[56:59] offset:128
    ds_write_b128 v15, v[60:63] offset:128
    v_lshlrev_b32 v72, 16, v124
    v_and_b32 v73, 0xffff0000, v124
    v_lshlrev_b32 v74, 16, v125
    v_and_b32 v75, 0xffff0000, v125
    v_lshlrev_b32 v76, 16, v126
    v_and_b32 v77, 0xffff0000, v126
    v_lshlrev_b32 v78, 16, v127
    v_and_b32 v79, 0xffff0000, v127
    v_add_f32 v64, v64, v72
    v_add_f32 v65, v65, v73
    v_add_f32 v66, v66, v74
    v_add_f32 v67, v67, v75
    v_add_f32 v68, v68, v76
    v_add_f32 v69, v69, v77
    v_add_f32 v70, v70, v78
    v_add_f32 v71, v71, v79
    s_waitcnt lgkmcnt(0)
    s_barrier
    ds_read_b128 v[128:131], v26 offset:0
    ds_read_b128 v[132:135], v27 offset:0
    ds_read_b128 v[136:139], v26 offset:16384
    ds_read_b128 v[140:143], v27 offset:16384
    ds_read_b128 v[144:147], v26 offset:32768
    ds_read_b128 v[148:151], v27 offset:32768
    ds_read_b128 v[152:155], v26 offset:49152
    ds_read_b128 v[156:159], v27 offset:49152
    s_waitcnt lgkmcnt(6)
    v_add_f32 v64, v64, v128
    v_add_f32 v65, v65, v129
    v_add_f32 v66, v66, v130
    v_add_f32 v67, v67, v131
    v_add_f32 v68, v68, v132
    v_add_f32 v69, v69, v133
    v_add_f32 v70, v70, v134
    v_add_f32 v71, v71, v135
    s_waitcnt lgkmcnt(4)
    v_add_f32 v64, v64, v136
    v_add_f32 v65, v65, v137
    v_add_f32 v66, v66, v138
    v_add_f32 v67, v67, v139
    v_add_f32 v68, v68, v140
    v_add_f32 v69, v69, v141
    v_add_f32 v70, v70, v142
    v_add_f32 v71, v71, v143
    s_waitcnt lgkmcnt(2)
    v_add_f32 v64, v64, v144
    v_add_f32 v65, v65, v145
    v_add_f32 v66, v66, v146
    v_add_f32 v67, v67, v147
    v_add_f32 v68, v68, v148
    v_add_f32 v69, v69, v149
    v_add_f32 v70, v70, v150
    v_add_f32 v71, v71, v151
    s_waitcnt lgkmcnt(0)
    v_add_f32 v64, v64, v152
    v_add_f32 v65, v65, v153
    v_add_f32 v66, v66, v154
    v_add_f32 v67, v67, v155
    v_add_f32 v68, v68, v156
    v_add_f32 v69, v69, v157
    v_add_f32 v70, v70, v158
    v_add_f32 v71, v71, v159
    v_cvt_pk_bf16_f32 v72, v64, v65
    v_cvt_pk_bf16_f32 v73, v66, v67
    v_cvt_pk_bf16_f32 v74, v68, v69
    v_cvt_pk_bf16_f32 v75, v70, v71
    buffer_store_dwordx4 v[72:75], v17, s[8:11], s57 offen sc1
    s_endpgm
.Lend:
    s_endpgm
.section .rodata,"a"
.p2align 6
.amdhsa_kernel parallel_sum__linear_kernel_hedgehog__dense_activation_squared_relu__prompt_kernel
  .amdhsa_next_free_vgpr 256
  .amdhsa_next_free_sgpr 102
  .amdhsa_accum_offset 256
  .amdhsa_group_segment_fixed_size 0
  .amdhsa_kernarg_size 96
  .amdhsa_user_sgpr_count 2
  .amdhsa_user_sgpr_kernarg_segment_ptr 1
  .amdhsa_system_sgpr_workgroup_id_x 1
.end_amdhsa_kernel
.p2align 7
tblw:
.long 0,128,256,384,512,640,768,896
.long 0,196608,393216,589824,786432,983040,1179648,1376256
.long 2048,2048,2048,1114112,16384,65536,0,8192
.long 8192,0,1048576,0,65536,0,2048,0
.long 0,128,256,384,512,640,768,896
.long 0,196608,393216,589824,786432,983040,1179648,1376256
.long 2176,2176,2176,1118208,16384,74240,8,8320
.long 8320,262144,2031616,256,74240,0,2176,0
.long 0,128,256,384,512,640,768,896
.long 0,196608,393216,589824,786432,983040,1179648,1376256
.long 2304,2304,2304,1122304,16384,82944,16,8448
.long 8448,524288,3014656,512,82944,0,2304,0
.long 0,128,256,384,512,640,768,896
.long 0,196608,393216,589824,786432,983040,1179648,1376256
.long 2432,2432,2432,1126400,16384,91648,24,8576
.long 8576,786432,3997696,768,91648,0,2432,0
.long 1048576,1048704,1048832,1048960,1049088,1049216,1049344,1049472
.long 0,196608,393216,589824,786432,983040,1179648,1376256
.long 2048,2048,2048,5046272,24576,65536,1024,8256
.long 8192,1048576,4980736,1024,69888,0,2048,0
.long 1048576,1048704,1048832,1048960,1049088,1049216,1049344,1049472
.long 0,196608,393216,589824,786432,983040,1179648,1376256
.long 2176,2176,2176,5050368,24576,74240,1032,8384
.long 8320,1310720,5963776,1280,78592,0,2176,0
.long 1048576,1048704,1048832,1048960,1049088,1049216,1049344,1049472
.long 0,196608,393216,589824,786432,983040,1179648,1376256
.long 2304,2304,2304,5054464,24576,82944,1040,8512
.long 8448,1572864,6946816,1536,87296,0,2304,0
.long 1048576,1048704,1048832,1048960,1049088,1049216,1049344,1049472
.long 0,196608,393216,589824,786432,983040,1179648,1376256
.long 2432,2432,2432,5058560,24576,91648,1048,8640
.long 8576,1835008,7929856,1792,96000,0,2432,0
.long 131200,131328,131456,131584,131712,131840,131968,131072
.long 196608,393216,589824,786432,983040,1179648,1376256,0
.long 2048,178176,2048,1605632,17408,65536,128,8200
.long 8192,128,1048576,0,66080,128,178176,2048
.long 131200,131328,131456,131584,131712,131840,131968,131072
.long 196608,393216,589824,786432,983040,1179648,1376256,0
.long 2176,178304,2176,1609728,17408,74240,136,8328
.long 8320,262272,2031616,256,74784,128,178304,2048
.long 131200,131328,131456,131584,131712,131840,131968,131072
.long 196608,393216,589824,786432,983040,1179648,1376256,0
.long 2304,178432,2304,1613824,17408,82944,144,8456
.long 8448,524416,3014656,512,83488,128,178432,2048
.long 131200,131328,131456,131584,131712,131840,131968,131072
.long 196608,393216,589824,786432,983040,1179648,1376256,0
.long 2432,178560,2432,1617920,17408,91648,152,8584
.long 8576,786560,3997696,768,92192,128,178560,2048
.long 1179776,1179904,1180032,1180160,1180288,1180416,1180544,1179648
.long 196608,393216,589824,786432,983040,1179648,1376256,0
.long 2048,178176,2048,5537792,25600,65536,1152,8264
.long 8192,1048704,4980736,1024,70432,128,178176,2048
.long 1179776,1179904,1180032,1180160,1180288,1180416,1180544,1179648
.long 196608,393216,589824,786432,983040,1179648,1376256,0
.long 2176,178304,2176,5541888,25600,74240,1160,8392
.long 8320,1310848,5963776,1280,79136,128,178304,2048
.long 1179776,1179904,1180032,1180160,1180288,1180416,1180544,1179648
.long 196608,393216,589824,786432,983040,1179648,1376256,0
.long 2304,178432,2304,5545984,25600,82944,1168,8520
.long 8448,1572992,6946816,1536,87840,128,178432,2048
.long 1179776,1179904,1180032,1180160,1180288,1180416,1180544,1179648
.long 196608,393216,589824,786432,983040,1179648,1376256,0
.long 2432,178560,2432,5550080,25600,91648,1176,8648
.long 8576,1835136,7929856,1792,96544,128,178560,2048
.long 262400,262528,262656,262784,262912,263040,262144,262272
.long 393216,589824,786432,983040,1179648,1376256,0,196608
.long 2048,354304,2048,2097152,18432,65536,256,8208
.long 8192,256,1048576,0,66624,256,354304,4096
.long 262400,262528,262656,262784,262912,263040,262144,262272
.long 393216,589824,786432,983040,1179648,1376256,0,196608
.long 2176,354432,2176,2101248,18432,74240,264,8336
.long 8320,262400,2031616,256,75328,256,354432,4096
.long 262400,262528,262656,262784,262912,263040,262144,262272
.long 393216,589824,786432,983040,1179648,1376256,0,196608
.long 2304,354560,2304,2105344,18432,82944,272,8464
.long 8448,524544,3014656,512,84032,256,354560,4096
.long 262400,262528,262656,262784,262912,263040,262144,262272
.long 393216,589824,786432,983040,1179648,1376256,0,196608
.long 2432,354688,2432,2109440,18432,91648,280,8592
.long 8576,786688,3997696,768,92736,256,354688,4096
.long 1310976,1311104,1311232,1311360,1311488,1311616,1310720,1310848
.long 393216,589824,786432,983040,1179648,1376256,0,196608
.long 2048,354304,2048,6029312,26624,65536,1280,8272
.long 8192,1048832,4980736,1024,70976,256,354304,4096
.long 1310976,1311104,1311232,1311360,1311488,1311616,1310720,1310848
.long 393216,589824,786432,983040,1179648,1376256,0,196608
.long 2176,354432,2176,6033408,26624,74240,1288,8400
.long 8320,1310976,5963776,1280,79680,256,354432,4096
.long 1310976,1311104,1311232,1311360,1311488,1311616,1310720,1310848
.long 393216,589824,786432,983040,1179648,1376256,0,196608
.long 2304,354560,2304,6037504,26624,82944,1296,8528
.long 8448,1573120,6946816,1536,88384,256,354560,4096
.long 1310976,1311104,1311232,1311360,1311488,1311616,1310720,1310848
.long 393216,589824,786432,983040,1179648,1376256,0,196608
.long 2432,354688,2432,6041600,26624,91648,1304,8656
.long 8576,1835264,7929856,1792,97088,256,354688,4096
.long 393600,393728,393856,393984,394112,393216,393344,393472
.long 589824,786432,983040,1179648,1376256,0,196608,393216
.long 2048,530432,2048,2588672,19456,65536,384,8216
.long 8192,384,1048576,0,67168,384,530432,6144
.long 393600,393728,393856,393984,394112,393216,393344,393472
.long 589824,786432,983040,1179648,1376256,0,196608,393216
.long 2176,530560,2176,2592768,19456,74240,392,8344
.long 8320,262528,2031616,256,75872,384,530560,6144
.long 393600,393728,393856,393984,394112,393216,393344,393472
.long 589824,786432,983040,1179648,1376256,0,196608,393216
.long 2304,530688,2304,2596864,19456,82944,400,8472
.long 8448,524672,3014656,512,84576,384,530688,6144
.long 393600,393728,393856,393984,394112,393216,393344,393472
.long 589824,786432,983040,1179648,1376256,0,196608,393216
.long 2432,530816,2432,2600960,19456,91648,408,8600
.long 8576,786816,3997696,768,93280,384,530816,6144
.long 1442176,1442304,1442432,1442560,1442688,1441792,1441920,1442048
.long 589824,786432,983040,1179648,1376256,0,196608,393216
.long 2048,530432,2048,6520832,27648,65536,1408,8280
.long 8192,1048960,4980736,1024,71520,384,530432,6144
.long 1442176,1442304,1442432,1442560,1442688,1441792,1441920,1442048
.long 589824,786432,983040,1179648,1376256,0,196608,393216
.long 2176,530560,2176,6524928,27648,74240,1416,8408
.long 8320,1311104,5963776,1280,80224,384,530560,6144
.long 1442176,1442304,1442432,1442560,1442688,1441792,1441920,1442048
.long 589824,786432,983040,1179648,1376256,0,196608,393216
.long 2304,530688,2304,6529024,27648,82944,1424,8536
.long 8448,1573248,6946816,1536,88928,384,530688,6144
.long 1442176,1442304,1442432,1442560,1442688,1441792,1441920,1442048
.long 589824,786432,983040,1179648,1376256,0,196608,393216
.long 2432,530816,2432,6533120,27648,91648,1432,8664
.long 8576,1835392,7929856,1792,97632,384,530816,6144
.long 524800,524928,525056,525184,524288,524416,524544,524672
.long 786432,983040,1179648,1376256,0,196608,393216,589824
.long 2048,706560,2048,3080192,20480,65536,512,8224
.long 8192,512,1048576,0,67712,512,706560,8192
.long 524800,524928,525056,525184,524288,524416,524544,524672
.long 786432,983040,1179648,1376256,0,196608,393216,589824
.long 2176,706688,2176,3084288,20480,74240,520,8352
.long 8320,262656,2031616,256,76416,512,706688,8192
.long 524800,524928,525056,525184,524288,524416,524544,524672
.long 786432,983040,1179648,1376256,0,196608,393216,589824
.long 2304,706816,2304,3088384,20480,82944,528,8480
.long 8448,524800,3014656,512,85120,512,706816,8192
.long 524800,524928,525056,525184,524288,524416,524544,524672
.long 786432,983040,1179648,1376256,0,196608,393216,589824
.long 2432,706944,2432,3092480,20480,91648,536,8608
.long 8576,786944,3997696,768,93824,512,706944,8192
.long 1573376,1573504,1573632,1573760,1572864,1572992,1573120,1573248
.long 786432,983040,1179648,1376256,0,196608,393216,589824
.long 2048,706560,2048,7012352,28672,65536,1536,8288
.long 8192,1049088,4980736,1024,72064,512,706560,8192
.long 1573376,1573504,1573632,1573760,1572864,1572992,1573120,1573248
.long 786432,983040,1179648,1376256,0,196608,393216,589824
.long 2176,706688,2176,7016448,28672,74240,1544,8416
.long 8320,1311232,5963776,1280,80768,512,706688,8192
.long 1573376,1573504,1573632,1573760,1572864,1572992,1573120,1573248
.long 786432,983040,1179648,1376256,0,196608,393216,589824
.long 2304,706816,2304,7020544,28672,82944,1552,8544
.long 8448,1573376,6946816,1536,89472,512,706816,8192
.long 1573376,1573504,1573632,1573760,1572864,1572992,1573120,1573248
.long 786432,983040,1179648,1376256,0,196608,393216,589824
.long 2432,706944,2432,7024640,28672,91648,1560,8672
.long 8576,1835520,7929856,1792,98176,512,706944,8192
.long 656000,656128,656256,655360,655488,655616,655744,655872
.long 983040,1179648,1376256,0,196608,393216,589824,786432
.long 2048,882688,2048,3571712,21504,65536,640,8232
.long 8192,640,1048576,0,68256,640,882688,10240
.long 656000,656128,656256,655360,655488,655616,655744,655872
.long 983040,1179648,1376256,0,196608,393216,589824,786432
.long 2176,882816,2176,3575808,21504,74240,648,8360
.long 8320,262784,2031616,256,76960,640,882816,10240
.long 656000,656128,656256,655360,655488,655616,655744,655872
.long 983040,1179648,1376256,0,196608,393216,589824,786432
.long 2304,882944,2304,3579904,21504,82944,656,8488
.long 8448,524928,3014656,512,85664,640,882944,10240
.long 656000,656128,656256,655360,655488,655616,655744,655872
.long 983040,1179648,1376256,0,196608,393216,589824,786432
.long 2432,883072,2432,3584000,21504,91648,664,8616
.long 8576,787072,3997696,768,94368,640,883072,10240
.long 1704576,1704704,1704832,1703936,1704064,1704192,1704320,1704448
.long 983040,1179648,1376256,0,196608,393216,589824,786432
.long 2048,882688,2048,7503872,29696,65536,1664,8296
.long 8192,1049216,4980736,1024,72608,640,882688,10240
.long 1704576,1704704,1704832,1703936,1704064,1704192,1704320,1704448
.long 983040,1179648,1376256,0,196608,393216,589824,786432
.long 2176,882816,2176,7507968,29696,74240,1672,8424
.long 8320,1311360,5963776,1280,81312,640,882816,10240
.long 1704576,1704704,1704832,1703936,1704064,1704192,1704320,1704448
.long 983040,1179648,1376256,0,196608,393216,589824,786432
.long 2304,882944,2304,7512064,29696,82944,1680,8552
.long 8448,1573504,6946816,1536,90016,640,882944,10240
.long 1704576,1704704,1704832,1703936,1704064,1704192,1704320,1704448
.long 983040,1179648,1376256,0,196608,393216,589824,786432
.long 2432,883072,2432,7516160,29696,91648,1688,8680
.long 8576,1835648,7929856,1792,98720,640,883072,10240
.long 787200,787328,786432,786560,786688,786816,786944,787072
.long 1179648,1376256,0,196608,393216,589824,786432,983040
.long 2048,1058816,2048,4063232,22528,65536,768,8240
.long 8192,768,1048576,0,68800,768,1058816,12288
.long 787200,787328,786432,786560,786688,786816,786944,787072
.long 1179648,1376256,0,196608,393216,589824,786432,983040
.long 2176,1058944,2176,4067328,22528,74240,776,8368
.long 8320,262912,2031616,256,77504,768,1058944,12288
.long 787200,787328,786432,786560,786688,786816,786944,787072
.long 1179648,1376256,0,196608,393216,589824,786432,983040
.long 2304,1059072,2304,4071424,22528,82944,784,8496
.long 8448,525056,3014656,512,86208,768,1059072,12288
.long 787200,787328,786432,786560,786688,786816,786944,787072
.long 1179648,1376256,0,196608,393216,589824,786432,983040
.long 2432,1059200,2432,4075520,22528,91648,792,8624
.long 8576,787200,3997696,768,94912,768,1059200,12288
.long 1835776,1835904,1835008,1835136,1835264,1835392,1835520,1835648
.long 1179648,1376256,0,196608,393216,589824,786432,983040
.long 2048,1058816,2048,7995392,30720,65536,1792,8304
.long 8192,1049344,4980736,1024,73152,768,1058816,12288
.long 1835776,1835904,1835008,1835136,1835264,1835392,1835520,1835648
.long 1179648,1376256,0,196608,393216,589824,786432,983040
.long 2176,1058944,2176,7999488,30720,74240,1800,8432
.long 8320,1311488,5963776,1280,81856,768,1058944,12288
.long 1835776,1835904,1835008,1835136,1835264,1835392,1835520,1835648
.long 1179648,1376256,0,196608,393216,589824,786432,983040
.long 2304,1059072,2304,8003584,30720,82944,1808,8560
.long 8448,1573632,6946816,1536,90560,768,1059072,12288
.long 1835776,1835904,1835008,1835136,1835264,1835392,1835520,1835648
.long 1179648,1376256,0,196608,393216,589824,786432,983040
.long 2432,1059200,2432,8007680,30720,91648,1816,8688
.long 8576,1835776,7929856,1792,99264,768,1059200,12288
.long 918400,917504,917632,917760,917888,918016,918144,918272
.long 1376256,0,196608,393216,589824,786432,983040,1179648
.long 2048,1234944,2048,4554752,23552,65536,896,8248
.long 8192,896,1048576,0,69344,896,1234944,14336
.long 918400,917504,917632,917760,917888,918016,918144,918272
.long 1376256,0,196608,393216,589824,786432,983040,1179648
.long 2176,1235072,2176,4558848,23552,74240,904,8376
.long 8320,263040,2031616,256,78048,896,1235072,14336
.long 918400,917504,917632,917760,917888,918016,918144,918272
.long 1376256,0,196608,393216,589824,786432,983040,1179648
.long 2304,1235200,2304,4562944,23552,82944,912,8504
.long 8448,525184,3014656,512,86752,896,1235200,14336
.long 918400,917504,917632,917760,917888,918016,918144,918272
.long 1376256,0,196608,393216,589824,786432,983040,1179648
.long 2432,1235328,2432,4567040,23552,91648,920,8632
.long 8576,787328,3997696,768,95456,896,1235328,14336
.long 1966976,1966080,1966208,1966336,1966464,1966592,1966720,1966848
.long 1376256,0,196608,393216,589824,786432,983040,1179648
.long 2048,1234944,2048,8486912,31744,65536,1920,8312
.long 8192,1049472,4980736,1024,73696,896,1234944,14336
.long 1966976,1966080,1966208,1966336,1966464,1966592,1966720,1966848
.long 1376256,0,196608,393216,589824,786432,983040,1179648
.long 2176,1235072,2176,8491008,31744,74240,1928,8440
.long 8320,1311616,5963776,1280,82400,896,1235072,14336
.long 1966976,1966080,1966208,1966336,1966464,1966592,1966720,1966848
.long 1376256,0,196608,393216,589824,786432,983040,1179648
.long 2304,1235200,2304,8495104,31744,82944,1936,8568
.long 8448,1573760,6946816,1536,91104,896,1235200,14336
.long 1966976,1966080,1966208,1966336,1966464,1966592,1966720,1966848
.long 1376256,0,196608,393216,589824,786432,983040,1179648
.long 2432,1235328,2432,8499200,31744,91648,1944,8696
.long 8576,1835904,7929856,1792,99808,896,1235328,14336
.long 256,384,512,640,768,896,0,128
.long 393216,589824,786432,983040,1179648,1376256,0,196608
.long 2496,2496,2496,1128448,16384,100352,32,8704
.long 8704,65536,1294336,0,100352,0,2496,512
.long 256,384,512,640,768,896,0,128
.long 393216,589824,786432,983040,1179648,1376256,0,196608
.long 2560,2560,2560,1130496,16384,109056,40,8832
.long 8832,327680,2277376,256,109056,0,2560,512
.long 256,384,512,640,768,896,0,128
.long 393216,589824,786432,983040,1179648,1376256,0,196608
.long 2624,2624,2624,1132544,16384,117760,48,8960
.long 8960,589824,3260416,512,117760,0,2624,512
.long 256,384,512,640,768,896,0,128
.long 393216,589824,786432,983040,1179648,1376256,0,196608
.long 2688,2688,2688,1134592,16384,126464,56,9088
.long 9088,851968,4243456,768,126464,0,2688,512
.long 1048832,1048960,1049088,1049216,1049344,1049472,1048576,1048704
.long 393216,589824,786432,983040,1179648,1376256,0,196608
.long 2496,2496,2496,5060608,24576,100352,1056,8768
.long 8704,1114112,5226496,1024,104704,0,2496,512
.long 1048832,1048960,1049088,1049216,1049344,1049472,1048576,1048704
.long 393216,589824,786432,983040,1179648,1376256,0,196608
.long 2560,2560,2560,5062656,24576,109056,1064,8896
.long 8832,1376256,6209536,1280,113408,0,2560,512
.long 1048832,1048960,1049088,1049216,1049344,1049472,1048576,1048704
.long 393216,589824,786432,983040,1179648,1376256,0,196608
.long 2624,2624,2624,5064704,24576,117760,1072,9024
.long 8960,1638400,7192576,1536,122112,0,2624,512
.long 1048832,1048960,1049088,1049216,1049344,1049472,1048576,1048704
.long 393216,589824,786432,983040,1179648,1376256,0,196608
.long 2688,2688,2688,5066752,24576,126464,1080,9152
.long 9088,1900544,8175616,1792,130816,0,2688,512
.long 131456,131584,131712,131840,131968,131072,131200,131328
.long 589824,786432,983040,1179648,1376256,0,196608,393216
.long 2496,178624,2496,1619968,17408,100352,160,8712
.long 8704,65664,1294336,0,100896,128,178624,2560
.long 131456,131584,131712,131840,131968,131072,131200,131328
.long 589824,786432,983040,1179648,1376256,0,196608,393216
.long 2560,178688,2560,1622016,17408,109056,168,8840
.long 8832,327808,2277376,256,109600,128,178688,2560
.long 131456,131584,131712,131840,131968,131072,131200,131328
.long 589824,786432,983040,1179648,1376256,0,196608,393216
.long 2624,178752,2624,1624064,17408,117760,176,8968
.long 8960,589952,3260416,512,118304,128,178752,2560
.long 131456,131584,131712,131840,131968,131072,131200,131328
.long 589824,786432,983040,1179648,1376256,0,196608,393216
.long 2688,178816,2688,1626112,17408,126464,184,9096
.long 9088,852096,4243456,768,127008,128,178816,2560
.long 1180032,1180160,1180288,1180416,1180544,1179648,1179776,1179904
.long 589824,786432,983040,1179648,1376256,0,196608,393216
.long 2496,178624,2496,5552128,25600,100352,1184,8776
.long 8704,1114240,5226496,1024,105248,128,178624,2560
.long 1180032,1180160,1180288,1180416,1180544,1179648,1179776,1179904
.long 589824,786432,983040,1179648,1376256,0,196608,393216
.long 2560,178688,2560,5554176,25600,109056,1192,8904
.long 8832,1376384,6209536,1280,113952,128,178688,2560
.long 1180032,1180160,1180288,1180416,1180544,1179648,1179776,1179904
.long 589824,786432,983040,1179648,1376256,0,196608,393216
.long 2624,178752,2624,5556224,25600,117760,1200,9032
.long 8960,1638528,7192576,1536,122656,128,178752,2560
.long 1180032,1180160,1180288,1180416,1180544,1179648,1179776,1179904
.long 589824,786432,983040,1179648,1376256,0,196608,393216
.long 2688,178816,2688,5558272,25600,126464,1208,9160
.long 9088,1900672,8175616,1792,131360,128,178816,2560
.long 262656,262784,262912,263040,262144,262272,262400,262528
.long 786432,983040,1179648,1376256,0,196608,393216,589824
.long 2496,354752,2496,2111488,18432,100352,288,8720
.long 8704,65792,1294336,0,101440,256,354752,4608
.long 262656,262784,262912,263040,262144,262272,262400,262528
.long 786432,983040,1179648,1376256,0,196608,393216,589824
.long 2560,354816,2560,2113536,18432,109056,296,8848
.long 8832,327936,2277376,256,110144,256,354816,4608
.long 262656,262784,262912,263040,262144,262272,262400,262528
.long 786432,983040,1179648,1376256,0,196608,393216,589824
.long 2624,354880,2624,2115584,18432,117760,304,8976
.long 8960,590080,3260416,512,118848,256,354880,4608
.long 262656,262784,262912,263040,262144,262272,262400,262528
.long 786432,983040,1179648,1376256,0,196608,393216,589824
.long 2688,354944,2688,2117632,18432,126464,312,9104
.long 9088,852224,4243456,768,127552,256,354944,4608
.long 1311232,1311360,1311488,1311616,1310720,1310848,1310976,1311104
.long 786432,983040,1179648,1376256,0,196608,393216,589824
.long 2496,354752,2496,6043648,26624,100352,1312,8784
.long 8704,1114368,5226496,1024,105792,256,354752,4608
.long 1311232,1311360,1311488,1311616,1310720,1310848,1310976,1311104
.long 786432,983040,1179648,1376256,0,196608,393216,589824
.long 2560,354816,2560,6045696,26624,109056,1320,8912
.long 8832,1376512,6209536,1280,114496,256,354816,4608
.long 1311232,1311360,1311488,1311616,1310720,1310848,1310976,1311104
.long 786432,983040,1179648,1376256,0,196608,393216,589824
.long 2624,354880,2624,6047744,26624,117760,1328,9040
.long 8960,1638656,7192576,1536,123200,256,354880,4608
.long 1311232,1311360,1311488,1311616,1310720,1310848,1310976,1311104
.long 786432,983040,1179648,1376256,0,196608,393216,589824
.long 2688,354944,2688,6049792,26624,126464,1336,9168
.long 9088,1900800,8175616,1792,131904,256,354944,4608
.long 393856,393984,394112,393216,393344,393472,393600,393728
.long 983040,1179648,1376256,0,196608,393216,589824,786432
.long 2496,530880,2496,2603008,19456,100352,416,8728
.long 8704,65920,1294336,0,101984,384,530880,6656
.long 393856,393984,394112,393216,393344,393472,393600,393728
.long 983040,1179648,1376256,0,196608,393216,589824,786432
.long 2560,530944,2560,2605056,19456,109056,424,8856
.long 8832,328064,2277376,256,110688,384,530944,6656
.long 393856,393984,394112,393216,393344,393472,393600,393728
.long 983040,1179648,1376256,0,196608,393216,589824,786432
.long 2624,531008,2624,2607104,19456,117760,432,8984
.long 8960,590208,3260416,512,119392,384,531008,6656
.long 393856,393984,394112,393216,393344,393472,393600,393728
.long 983040,1179648,1376256,0,196608,393216,589824,786432
.long 2688,531072,2688,2609152,19456,126464,440,9112
.long 9088,852352,4243456,768,128096,384,531072,6656
.long 1442432,1442560,1442688,1441792,1441920,1442048,1442176,1442304
.long 983040,1179648,1376256,0,196608,393216,589824,786432
.long 2496,530880,2496,6535168,27648,100352,1440,8792
.long 8704,1114496,5226496,1024,106336,384,530880,6656
.long 1442432,1442560,1442688,1441792,1441920,1442048,1442176,1442304
.long 983040,1179648,1376256,0,196608,393216,589824,786432
.long 2560,530944,2560,6537216,27648,109056,1448,8920
.long 8832,1376640,6209536,1280,115040,384,530944,6656
.long 1442432,1442560,1442688,1441792,1441920,1442048,1442176,1442304
.long 983040,1179648,1376256,0,196608,393216,589824,786432
.long 2624,531008,2624,6539264,27648,117760,1456,9048
.long 8960,1638784,7192576,1536,123744,384,531008,6656
.long 1442432,1442560,1442688,1441792,1441920,1442048,1442176,1442304
.long 983040,1179648,1376256,0,196608,393216,589824,786432
.long 2688,531072,2688,6541312,27648,126464,1464,9176
.long 9088,1900928,8175616,1792,132448,384,531072,6656
.long 525056,525184,524288,524416,524544,524672,524800,524928
.long 1179648,1376256,0,196608,393216,589824,786432,983040
.long 2496,707008,2496,3094528,20480,100352,544,8736
.long 8704,66048,1294336,0,102528,512,707008,8704
.long 525056,525184,524288,524416,524544,524672,524800,524928
.long 1179648,1376256,0,196608,393216,589824,786432,983040
.long 2560,707072,2560,3096576,20480,109056,552,8864
.long 8832,328192,2277376,256,111232,512,707072,8704
.long 525056,525184,524288,524416,524544,524672,524800,524928
.long 1179648,1376256,0,196608,393216,589824,786432,983040
.long 2624,707136,2624,3098624,20480,117760,560,8992
.long 8960,590336,3260416,512,119936,512,707136,8704
.long 525056,525184,524288,524416,524544,524672,524800,524928
.long 1179648,1376256,0,196608,393216,589824,786432,983040
.long 2688,707200,2688,3100672,20480,126464,568,9120
.long 9088,852480,4243456,768,128640,512,707200,8704
.long 1573632,1573760,1572864,1572992,1573120,1573248,1573376,1573504
.long 1179648,1376256,0,196608,393216,589824,786432,983040
.long 2496,707008,2496,7026688,28672,100352,1568,8800
.long 8704,1114624,5226496,1024,106880,512,707008,8704
.long 1573632,1573760,1572864,1572992,1573120,1573248,1573376,1573504
.long 1179648,1376256,0,196608,393216,589824,786432,983040
.long 2560,707072,2560,7028736,28672,109056,1576,8928
.long 8832,1376768,6209536,1280,115584,512,707072,8704
.long 1573632,1573760,1572864,1572992,1573120,1573248,1573376,1573504
.long 1179648,1376256,0,196608,393216,589824,786432,983040
.long 2624,707136,2624,7030784,28672,117760,1584,9056
.long 8960,1638912,7192576,1536,124288,512,707136,8704
.long 1573632,1573760,1572864,1572992,1573120,1573248,1573376,1573504
.long 1179648,1376256,0,196608,393216,589824,786432,983040
.long 2688,707200,2688,7032832,28672,126464,1592,9184
.long 9088,1901056,8175616,1792,132992,512,707200,8704
.long 656256,655360,655488,655616,655744,655872,656000,656128
.long 1376256,0,196608,393216,589824,786432,983040,1179648
.long 2496,883136,2496,3586048,21504,100352,672,8744
.long 8704,66176,1294336,0,103072,640,883136,10752
.long 656256,655360,655488,655616,655744,655872,656000,656128
.long 1376256,0,196608,393216,589824,786432,983040,1179648
.long 2560,883200,2560,3588096,21504,109056,680,8872
.long 8832,328320,2277376,256,111776,640,883200,10752
.long 656256,655360,655488,655616,655744,655872,656000,656128
.long 1376256,0,196608,393216,589824,786432,983040,1179648
.long 2624,883264,2624,3590144,21504,117760,688,9000
.long 8960,590464,3260416,512,120480,640,883264,10752
.long 656256,655360,655488,655616,655744,655872,656000,656128
.long 1376256,0,196608,393216,589824,786432,983040,1179648
.long 2688,883328,2688,3592192,21504,126464,696,9128
.long 9088,852608,4243456,768,129184,640,883328,10752
.long 1704832,1703936,1704064,1704192,1704320,1704448,1704576,1704704
.long 1376256,0,196608,393216,589824,786432,983040,1179648
.long 2496,883136,2496,7518208,29696,100352,1696,8808
.long 8704,1114752,5226496,1024,107424,640,883136,10752
.long 1704832,1703936,1704064,1704192,1704320,1704448,1704576,1704704
.long 1376256,0,196608,393216,589824,786432,983040,1179648
.long 2560,883200,2560,7520256,29696,109056,1704,8936
.long 8832,1376896,6209536,1280,116128,640,883200,10752
.long 1704832,1703936,1704064,1704192,1704320,1704448,1704576,1704704
.long 1376256,0,196608,393216,589824,786432,983040,1179648
.long 2624,883264,2624,7522304,29696,117760,1712,9064
.long 8960,1639040,7192576,1536,124832,640,883264,10752
.long 1704832,1703936,1704064,1704192,1704320,1704448,1704576,1704704
.long 1376256,0,196608,393216,589824,786432,983040,1179648
.long 2688,883328,2688,7524352,29696,126464,1720,9192
.long 9088,1901184,8175616,1792,133536,640,883328,10752
.long 786432,786560,786688,786816,786944,787072,787200,787328
.long 0,196608,393216,589824,786432,983040,1179648,1376256
.long 2496,1059264,2496,4077568,22528,100352,800,8752
.long 8704,66304,1294336,0,103616,768,1059264,12800
.long 786432,786560,786688,786816,786944,787072,787200,787328
.long 0,196608,393216,589824,786432,983040,1179648,1376256
.long 2560,1059328,2560,4079616,22528,109056,808,8880
.long 8832,328448,2277376,256,112320,768,1059328,12800
.long 786432,786560,786688,786816,786944,787072,787200,787328
.long 0,196608,393216,589824,786432,983040,1179648,1376256
.long 2624,1059392,2624,4081664,22528,117760,816,9008
.long 8960,590592,3260416,512,121024,768,1059392,12800
.long 786432,786560,786688,786816,786944,787072,787200,787328
.long 0,196608,393216,589824,786432,983040,1179648,1376256
.long 2688,1059456,2688,4083712,22528,126464,824,9136
.long 9088,852736,4243456,768,129728,768,1059456,12800
.long 1835008,1835136,1835264,1835392,1835520,1835648,1835776,1835904
.long 0,196608,393216,589824,786432,983040,1179648,1376256
.long 2496,1059264,2496,8009728,30720,100352,1824,8816
.long 8704,1114880,5226496,1024,107968,768,1059264,12800
.long 1835008,1835136,1835264,1835392,1835520,1835648,1835776,1835904
.long 0,196608,393216,589824,786432,983040,1179648,1376256
.long 2560,1059328,2560,8011776,30720,109056,1832,8944
.long 8832,1377024,6209536,1280,116672,768,1059328,12800
.long 1835008,1835136,1835264,1835392,1835520,1835648,1835776,1835904
.long 0,196608,393216,589824,786432,983040,1179648,1376256
.long 2624,1059392,2624,8013824,30720,117760,1840,9072
.long 8960,1639168,7192576,1536,125376,768,1059392,12800
.long 1835008,1835136,1835264,1835392,1835520,1835648,1835776,1835904
.long 0,196608,393216,589824,786432,983040,1179648,1376256
.long 2688,1059456,2688,8015872,30720,126464,1848,9200
.long 9088,1901312,8175616,1792,134080,768,1059456,12800
.long 917632,917760,917888,918016,918144,918272,918400,917504
.long 196608,393216,589824,786432,983040,1179648,1376256,0
.long 2496,1235392,2496,4569088,23552,100352,928,8760
.long 8704,66432,1294336,0,104160,896,1235392,14848
.long 917632,917760,917888,918016,918144,918272,918400,917504
.long 196608,393216,589824,786432,983040,1179648,1376256,0
.long 2560,1235456,2560,4571136,23552,109056,936,8888
.long 8832,328576,2277376,256,112864,896,1235456,14848
.long 917632,917760,917888,918016,918144,918272,918400,917504
.long 196608,393216,589824,786432,983040,1179648,1376256,0
.long 2624,1235520,2624,4573184,23552,117760,944,9016
.long 8960,590720,3260416,512,121568,896,1235520,14848
.long 917632,917760,917888,918016,918144,918272,918400,917504
.long 196608,393216,589824,786432,983040,1179648,1376256,0
.long 2688,1235584,2688,4575232,23552,126464,952,9144
.long 9088,852864,4243456,768,130272,896,1235584,14848
.long 1966208,1966336,1966464,1966592,1966720,1966848,1966976,1966080
.long 196608,393216,589824,786432,983040,1179648,1376256,0
.long 2496,1235392,2496,8501248,31744,100352,1952,8824
.long 8704,1115008,5226496,1024,108512,896,1235392,14848
.long 1966208,1966336,1966464,1966592,1966720,1966848,1966976,1966080
.long 196608,393216,589824,786432,983040,1179648,1376256,0
.long 2560,1235456,2560,8503296,31744,109056,1960,8952
.long 8832,1377152,6209536,1280,117216,896,1235456,14848
.long 1966208,1966336,1966464,1966592,1966720,1966848,1966976,1966080
.long 196608,393216,589824,786432,983040,1179648,1376256,0
.long 2624,1235520,2624,8505344,31744,117760,1968,9080
.long 8960,1639296,7192576,1536,125920,896,1235520,14848
.long 1966208,1966336,1966464,1966592,1966720,1966848,1966976,1966080
.long 196608,393216,589824,786432,983040,1179648,1376256,0
.long 2688,1235584,2688,8507392,31744,126464,1976,9208
.long 9088,1901440,8175616,1792,134624,896,1235584,14848
.long 512,640,768,896,0,128,256,384
.long 786432,983040,1179648,1376256,0,196608,393216,589824
.long 128,128,0,1048576,16384,65536,64,4096
.long 8192,131072,1540096,128,1138688,0,2048,1024
.long 512,640,768,896,0,128,256,384
.long 786432,983040,1179648,1376256,0,196608,393216,589824
.long 384,384,256,1056768,16384,74240,72,4104
.long 8320,393216,2523136,384,1142784,0,2176,1024
.long 512,640,768,896,0,128,256,384
.long 786432,983040,1179648,1376256,0,196608,393216,589824
.long 640,640,512,1064960,16384,82944,80,4112
.long 8448,655360,3506176,640,1146880,0,2304,1024
.long 512,640,768,896,0,128,256,384
.long 786432,983040,1179648,1376256,0,196608,393216,589824
.long 896,896,768,1073152,16384,91648,88,4120
.long 8576,917504,4489216,896,1150976,0,2432,1024
.long 1049088,1049216,1049344,1049472,1048576,1048704,1048832,1048960
.long 786432,983040,1179648,1376256,0,196608,393216,589824
.long 128,128,0,4980736,24576,65536,1088,5120
.long 8192,1179648,5472256,1152,5070848,0,2048,1024
.long 1049088,1049216,1049344,1049472,1048576,1048704,1048832,1048960
.long 786432,983040,1179648,1376256,0,196608,393216,589824
.long 384,384,256,4988928,24576,74240,1096,5128
.long 8320,1441792,6455296,1408,5074944,0,2176,1024
.long 1049088,1049216,1049344,1049472,1048576,1048704,1048832,1048960
.long 786432,983040,1179648,1376256,0,196608,393216,589824
.long 640,640,512,4997120,24576,82944,1104,5136
.long 8448,1703936,7438336,1664,5079040,0,2304,1024
.long 1049088,1049216,1049344,1049472,1048576,1048704,1048832,1048960
.long 786432,983040,1179648,1376256,0,196608,393216,589824
.long 896,896,768,5005312,24576,91648,1112,5144
.long 8576,1966080,8421376,1920,5083136,0,2432,1024
.long 131712,131840,131968,131072,131200,131328,131456,131584
.long 983040,1179648,1376256,0,196608,393216,589824,786432
.long 128,176256,0,1540096,17408,65536,192,4224
.long 8192,131200,1540096,128,1630208,128,178176,3072
.long 131712,131840,131968,131072,131200,131328,131456,131584
.long 983040,1179648,1376256,0,196608,393216,589824,786432
.long 384,176512,256,1548288,17408,74240,200,4232
.long 8320,393344,2523136,384,1634304,128,178304,3072
.long 131712,131840,131968,131072,131200,131328,131456,131584
.long 983040,1179648,1376256,0,196608,393216,589824,786432
.long 640,176768,512,1556480,17408,82944,208,4240
.long 8448,655488,3506176,640,1638400,128,178432,3072
.long 131712,131840,131968,131072,131200,131328,131456,131584
.long 983040,1179648,1376256,0,196608,393216,589824,786432
.long 896,177024,768,1564672,17408,91648,216,4248
.long 8576,917632,4489216,896,1642496,128,178560,3072
.long 1180288,1180416,1180544,1179648,1179776,1179904,1180032,1180160
.long 983040,1179648,1376256,0,196608,393216,589824,786432
.long 128,176256,0,5472256,25600,65536,1216,5248
.long 8192,1179776,5472256,1152,5562368,128,178176,3072
.long 1180288,1180416,1180544,1179648,1179776,1179904,1180032,1180160
.long 983040,1179648,1376256,0,196608,393216,589824,786432
.long 384,176512,256,5480448,25600,74240,1224,5256
.long 8320,1441920,6455296,1408,5566464,128,178304,3072
.long 1180288,1180416,1180544,1179648,1179776,1179904,1180032,1180160
.long 983040,1179648,1376256,0,196608,393216,589824,786432
.long 640,176768,512,5488640,25600,82944,1232,5264
.long 8448,1704064,7438336,1664,5570560,128,178432,3072
.long 1180288,1180416,1180544,1179648,1179776,1179904,1180032,1180160
.long 983040,1179648,1376256,0,196608,393216,589824,786432
.long 896,177024,768,5496832,25600,91648,1240,5272
.long 8576,1966208,8421376,1920,5574656,128,178560,3072
.long 262912,263040,262144,262272,262400,262528,262656,262784
.long 1179648,1376256,0,196608,393216,589824,786432,983040
.long 128,352384,0,2031616,18432,65536,320,4352
.long 8192,131328,1540096,128,2121728,256,354304,5120
.long 262912,263040,262144,262272,262400,262528,262656,262784
.long 1179648,1376256,0,196608,393216,589824,786432,983040
.long 384,352640,256,2039808,18432,74240,328,4360
.long 8320,393472,2523136,384,2125824,256,354432,5120
.long 262912,263040,262144,262272,262400,262528,262656,262784
.long 1179648,1376256,0,196608,393216,589824,786432,983040
.long 640,352896,512,2048000,18432,82944,336,4368
.long 8448,655616,3506176,640,2129920,256,354560,5120
.long 262912,263040,262144,262272,262400,262528,262656,262784
.long 1179648,1376256,0,196608,393216,589824,786432,983040
.long 896,353152,768,2056192,18432,91648,344,4376
.long 8576,917760,4489216,896,2134016,256,354688,5120
.long 1311488,1311616,1310720,1310848,1310976,1311104,1311232,1311360
.long 1179648,1376256,0,196608,393216,589824,786432,983040
.long 128,352384,0,5963776,26624,65536,1344,5376
.long 8192,1179904,5472256,1152,6053888,256,354304,5120
.long 1311488,1311616,1310720,1310848,1310976,1311104,1311232,1311360
.long 1179648,1376256,0,196608,393216,589824,786432,983040
.long 384,352640,256,5971968,26624,74240,1352,5384
.long 8320,1442048,6455296,1408,6057984,256,354432,5120
.long 1311488,1311616,1310720,1310848,1310976,1311104,1311232,1311360
.long 1179648,1376256,0,196608,393216,589824,786432,983040
.long 640,352896,512,5980160,26624,82944,1360,5392
.long 8448,1704192,7438336,1664,6062080,256,354560,5120
.long 1311488,1311616,1310720,1310848,1310976,1311104,1311232,1311360
.long 1179648,1376256,0,196608,393216,589824,786432,983040
.long 896,353152,768,5988352,26624,91648,1368,5400
.long 8576,1966336,8421376,1920,6066176,256,354688,5120
.long 394112,393216,393344,393472,393600,393728,393856,393984
.long 1376256,0,196608,393216,589824,786432,983040,1179648
.long 128,528512,0,2523136,19456,65536,448,4480
.long 8192,131456,1540096,128,2613248,384,530432,7168
.long 394112,393216,393344,393472,393600,393728,393856,393984
.long 1376256,0,196608,393216,589824,786432,983040,1179648
.long 384,528768,256,2531328,19456,74240,456,4488
.long 8320,393600,2523136,384,2617344,384,530560,7168
.long 394112,393216,393344,393472,393600,393728,393856,393984
.long 1376256,0,196608,393216,589824,786432,983040,1179648
.long 640,529024,512,2539520,19456,82944,464,4496
.long 8448,655744,3506176,640,2621440,384,530688,7168
.long 394112,393216,393344,393472,393600,393728,393856,393984
.long 1376256,0,196608,393216,589824,786432,983040,1179648
.long 896,529280,768,2547712,19456,91648,472,4504
.long 8576,917888,4489216,896,2625536,384,530816,7168
.long 1442688,1441792,1441920,1442048,1442176,1442304,1442432,1442560
.long 1376256,0,196608,393216,589824,786432,983040,1179648
.long 128,528512,0,6455296,27648,65536,1472,5504
.long 8192,1180032,5472256,1152,6545408,384,530432,7168
.long 1442688,1441792,1441920,1442048,1442176,1442304,1442432,1442560
.long 1376256,0,196608,393216,589824,786432,983040,1179648
.long 384,528768,256,6463488,27648,74240,1480,5512
.long 8320,1442176,6455296,1408,6549504,384,530560,7168
.long 1442688,1441792,1441920,1442048,1442176,1442304,1442432,1442560
.long 1376256,0,196608,393216,589824,786432,983040,1179648
.long 640,529024,512,6471680,27648,82944,1488,5520
.long 8448,1704320,7438336,1664,6553600,384,530688,7168
.long 1442688,1441792,1441920,1442048,1442176,1442304,1442432,1442560
.long 1376256,0,196608,393216,589824,786432,983040,1179648
.long 896,529280,768,6479872,27648,91648,1496,5528
.long 8576,1966464,8421376,1920,6557696,384,530816,7168
.long 524288,524416,524544,524672,524800,524928,525056,525184
.long 0,196608,393216,589824,786432,983040,1179648,1376256
.long 128,704640,0,3014656,20480,65536,576,4608
.long 8192,131584,1540096,128,3104768,512,706560,9216
.long 524288,524416,524544,524672,524800,524928,525056,525184
.long 0,196608,393216,589824,786432,983040,1179648,1376256
.long 384,704896,256,3022848,20480,74240,584,4616
.long 8320,393728,2523136,384,3108864,512,706688,9216
.long 524288,524416,524544,524672,524800,524928,525056,525184
.long 0,196608,393216,589824,786432,983040,1179648,1376256
.long 640,705152,512,3031040,20480,82944,592,4624
.long 8448,655872,3506176,640,3112960,512,706816,9216
.long 524288,524416,524544,524672,524800,524928,525056,525184
.long 0,196608,393216,589824,786432,983040,1179648,1376256
.long 896,705408,768,3039232,20480,91648,600,4632
.long 8576,918016,4489216,896,3117056,512,706944,9216
.long 1572864,1572992,1573120,1573248,1573376,1573504,1573632,1573760
.long 0,196608,393216,589824,786432,983040,1179648,1376256
.long 128,704640,0,6946816,28672,65536,1600,5632
.long 8192,1180160,5472256,1152,7036928,512,706560,9216
.long 1572864,1572992,1573120,1573248,1573376,1573504,1573632,1573760
.long 0,196608,393216,589824,786432,983040,1179648,1376256
.long 384,704896,256,6955008,28672,74240,1608,5640
.long 8320,1442304,6455296,1408,7041024,512,706688,9216
.long 1572864,1572992,1573120,1573248,1573376,1573504,1573632,1573760
.long 0,196608,393216,589824,786432,983040,1179648,1376256
.long 640,705152,512,6963200,28672,82944,1616,5648
.long 8448,1704448,7438336,1664,7045120,512,706816,9216
.long 1572864,1572992,1573120,1573248,1573376,1573504,1573632,1573760
.long 0,196608,393216,589824,786432,983040,1179648,1376256
.long 896,705408,768,6971392,28672,91648,1624,5656
.long 8576,1966592,8421376,1920,7049216,512,706944,9216
.long 655488,655616,655744,655872,656000,656128,656256,655360
.long 196608,393216,589824,786432,983040,1179648,1376256,0
.long 128,880768,0,3506176,21504,65536,704,4736
.long 8192,131712,1540096,128,3596288,640,882688,11264
.long 655488,655616,655744,655872,656000,656128,656256,655360
.long 196608,393216,589824,786432,983040,1179648,1376256,0
.long 384,881024,256,3514368,21504,74240,712,4744
.long 8320,393856,2523136,384,3600384,640,882816,11264
.long 655488,655616,655744,655872,656000,656128,656256,655360
.long 196608,393216,589824,786432,983040,1179648,1376256,0
.long 640,881280,512,3522560,21504,82944,720,4752
.long 8448,656000,3506176,640,3604480,640,882944,11264
.long 655488,655616,655744,655872,656000,656128,656256,655360
.long 196608,393216,589824,786432,983040,1179648,1376256,0
.long 896,881536,768,3530752,21504,91648,728,4760
.long 8576,918144,4489216,896,3608576,640,883072,11264
.long 1704064,1704192,1704320,1704448,1704576,1704704,1704832,1703936
.long 196608,393216,589824,786432,983040,1179648,1376256,0
.long 128,880768,0,7438336,29696,65536,1728,5760
.long 8192,1180288,5472256,1152,7528448,640,882688,11264
.long 1704064,1704192,1704320,1704448,1704576,1704704,1704832,1703936
.long 196608,393216,589824,786432,983040,1179648,1376256,0
.long 384,881024,256,7446528,29696,74240,1736,5768
.long 8320,1442432,6455296,1408,7532544,640,882816,11264
.long 1704064,1704192,1704320,1704448,1704576,1704704,1704832,1703936
.long 196608,393216,589824,786432,983040,1179648,1376256,0
.long 640,881280,512,7454720,29696,82944,1744,5776
.long 8448,1704576,7438336,1664,7536640,640,882944,11264
.long 1704064,1704192,1704320,1704448,1704576,1704704,1704832,1703936
.long 196608,393216,589824,786432,983040,1179648,1376256,0
.long 896,881536,768,7462912,29696,91648,1752,5784
.long 8576,1966720,8421376,1920,7540736,640,883072,11264
.long 786688,786816,786944,787072,787200,787328,786432,786560
.long 393216,589824,786432,983040,1179648,1376256,0,196608
.long 128,1056896,0,3997696,22528,65536,832,4864
.long 8192,131840,1540096,128,4087808,768,1058816,13312
.long 786688,786816,786944,787072,787200,787328,786432,786560
.long 393216,589824,786432,983040,1179648,1376256,0,196608
.long 384,1057152,256,4005888,22528,74240,840,4872
.long 8320,393984,2523136,384,4091904,768,1058944,13312
.long 786688,786816,786944,787072,787200,787328,786432,786560
.long 393216,589824,786432,983040,1179648,1376256,0,196608
.long 640,1057408,512,4014080,22528,82944,848,4880
.long 8448,656128,3506176,640,4096000,768,1059072,13312
.long 786688,786816,786944,787072,787200,787328,786432,786560
.long 393216,589824,786432,983040,1179648,1376256,0,196608
.long 896,1057664,768,4022272,22528,91648,856,4888
.long 8576,918272,4489216,896,4100096,768,1059200,13312
.long 1835264,1835392,1835520,1835648,1835776,1835904,1835008,1835136
.long 393216,589824,786432,983040,1179648,1376256,0,196608
.long 128,1056896,0,7929856,30720,65536,1856,5888
.long 8192,1180416,5472256,1152,8019968,768,1058816,13312
.long 1835264,1835392,1835520,1835648,1835776,1835904,1835008,1835136
.long 393216,589824,786432,983040,1179648,1376256,0,196608
.long 384,1057152,256,7938048,30720,74240,1864,5896
.long 8320,1442560,6455296,1408,8024064,768,1058944,13312
.long 1835264,1835392,1835520,1835648,1835776,1835904,1835008,1835136
.long 393216,589824,786432,983040,1179648,1376256,0,196608
.long 640,1057408,512,7946240,30720,82944,1872,5904
.long 8448,1704704,7438336,1664,8028160,768,1059072,13312
.long 1835264,1835392,1835520,1835648,1835776,1835904,1835008,1835136
.long 393216,589824,786432,983040,1179648,1376256,0,196608
.long 896,1057664,768,7954432,30720,91648,1880,5912
.long 8576,1966848,8421376,1920,8032256,768,1059200,13312
.long 917888,918016,918144,918272,918400,917504,917632,917760
.long 589824,786432,983040,1179648,1376256,0,196608,393216
.long 128,1233024,0,4489216,23552,65536,960,4992
.long 8192,131968,1540096,128,4579328,896,1234944,15360
.long 917888,918016,918144,918272,918400,917504,917632,917760
.long 589824,786432,983040,1179648,1376256,0,196608,393216
.long 384,1233280,256,4497408,23552,74240,968,5000
.long 8320,394112,2523136,384,4583424,896,1235072,15360
.long 917888,918016,918144,918272,918400,917504,917632,917760
.long 589824,786432,983040,1179648,1376256,0,196608,393216
.long 640,1233536,512,4505600,23552,82944,976,5008
.long 8448,656256,3506176,640,4587520,896,1235200,15360
.long 917888,918016,918144,918272,918400,917504,917632,917760
.long 589824,786432,983040,1179648,1376256,0,196608,393216
.long 896,1233792,768,4513792,23552,91648,984,5016
.long 8576,918400,4489216,896,4591616,896,1235328,15360
.long 1966464,1966592,1966720,1966848,1966976,1966080,1966208,1966336
.long 589824,786432,983040,1179648,1376256,0,196608,393216
.long 128,1233024,0,8421376,31744,65536,1984,6016
.long 8192,1180544,5472256,1152,8511488,896,1234944,15360
.long 1966464,1966592,1966720,1966848,1966976,1966080,1966208,1966336
.long 589824,786432,983040,1179648,1376256,0,196608,393216
.long 384,1233280,256,8429568,31744,74240,1992,6024
.long 8320,1442688,6455296,1408,8515584,896,1235072,15360
.long 1966464,1966592,1966720,1966848,1966976,1966080,1966208,1966336
.long 589824,786432,983040,1179648,1376256,0,196608,393216
.long 640,1233536,512,8437760,31744,82944,2000,6032
.long 8448,1704832,7438336,1664,8519680,896,1235200,15360
.long 1966464,1966592,1966720,1966848,1966976,1966080,1966208,1966336
.long 589824,786432,983040,1179648,1376256,0,196608,393216
.long 896,1233792,768,8445952,31744,91648,2008,6040
.long 8576,1966976,8421376,1920,8523776,896,1235328,15360
.long 768,896,0,128,256,384,512,640
.long 1179648,1376256,0,196608,393216,589824,786432,983040
.long 1152,1152,1024,1081344,16384,100352,96,4128
.long 8704,196608,1785856,128,1155072,0,2496,1536
.long 768,896,0,128,256,384,512,640
.long 1179648,1376256,0,196608,393216,589824,786432,983040
.long 1408,1408,1280,1089536,16384,109056,104,4136
.long 8832,458752,2768896,384,1159168,0,2560,1536
.long 768,896,0,128,256,384,512,640
.long 1179648,1376256,0,196608,393216,589824,786432,983040
.long 1664,1664,1536,1097728,16384,117760,112,4144
.long 8960,720896,3751936,640,1163264,0,2624,1536
.long 768,896,0,128,256,384,512,640
.long 1179648,1376256,0,196608,393216,589824,786432,983040
.long 1920,1920,1792,1105920,16384,126464,120,4152
.long 9088,983040,4734976,896,1167360,0,2688,1536
.long 1049344,1049472,1048576,1048704,1048832,1048960,1049088,1049216
.long 1179648,1376256,0,196608,393216,589824,786432,983040
.long 1152,1152,1024,5013504,24576,100352,1120,5152
.long 8704,1245184,5718016,1152,5087232,0,2496,1536
.long 1049344,1049472,1048576,1048704,1048832,1048960,1049088,1049216
.long 1179648,1376256,0,196608,393216,589824,786432,983040
.long 1408,1408,1280,5021696,24576,109056,1128,5160
.long 8832,1507328,6701056,1408,5091328,0,2560,1536
.long 1049344,1049472,1048576,1048704,1048832,1048960,1049088,1049216
.long 1179648,1376256,0,196608,393216,589824,786432,983040
.long 1664,1664,1536,5029888,24576,117760,1136,5168
.long 8960,1769472,7684096,1664,5095424,0,2624,1536
.long 1049344,1049472,1048576,1048704,1048832,1048960,1049088,1049216
.long 1179648,1376256,0,196608,393216,589824,786432,983040
.long 1920,1920,1792,5038080,24576,126464,1144,5176
.long 9088,2031616,8667136,1920,5099520,0,2688,1536
.long 131968,131072,131200,131328,131456,131584,131712,131840
.long 1376256,0,196608,393216,589824,786432,983040,1179648
.long 1152,177280,1024,1572864,17408,100352,224,4256
.long 8704,196736,1785856,128,1646592,128,178624,3584
.long 131968,131072,131200,131328,131456,131584,131712,131840
.long 1376256,0,196608,393216,589824,786432,983040,1179648
.long 1408,177536,1280,1581056,17408,109056,232,4264
.long 8832,458880,2768896,384,1650688,128,178688,3584
.long 131968,131072,131200,131328,131456,131584,131712,131840
.long 1376256,0,196608,393216,589824,786432,983040,1179648
.long 1664,177792,1536,1589248,17408,117760,240,4272
.long 8960,721024,3751936,640,1654784,128,178752,3584
.long 131968,131072,131200,131328,131456,131584,131712,131840
.long 1376256,0,196608,393216,589824,786432,983040,1179648
.long 1920,178048,1792,1597440,17408,126464,248,4280
.long 9088,983168,4734976,896,1658880,128,178816,3584
.long 1180544,1179648,1179776,1179904,1180032,1180160,1180288,1180416
.long 1376256,0,196608,393216,589824,786432,983040,1179648
.long 1152,177280,1024,5505024,25600,100352,1248,5280
.long 8704,1245312,5718016,1152,5578752,128,178624,3584
.long 1180544,1179648,1179776,1179904,1180032,1180160,1180288,1180416
.long 1376256,0,196608,393216,589824,786432,983040,1179648
.long 1408,177536,1280,5513216,25600,109056,1256,5288
.long 8832,1507456,6701056,1408,5582848,128,178688,3584
.long 1180544,1179648,1179776,1179904,1180032,1180160,1180288,1180416
.long 1376256,0,196608,393216,589824,786432,983040,1179648
.long 1664,177792,1536,5521408,25600,117760,1264,5296
.long 8960,1769600,7684096,1664,5586944,128,178752,3584
.long 1180544,1179648,1179776,1179904,1180032,1180160,1180288,1180416
.long 1376256,0,196608,393216,589824,786432,983040,1179648
.long 1920,178048,1792,5529600,25600,126464,1272,5304
.long 9088,2031744,8667136,1920,5591040,128,178816,3584
.long 262144,262272,262400,262528,262656,262784,262912,263040
.long 0,196608,393216,589824,786432,983040,1179648,1376256
.long 1152,353408,1024,2064384,18432,100352,352,4384
.long 8704,196864,1785856,128,2138112,256,354752,5632
.long 262144,262272,262400,262528,262656,262784,262912,263040
.long 0,196608,393216,589824,786432,983040,1179648,1376256
.long 1408,353664,1280,2072576,18432,109056,360,4392
.long 8832,459008,2768896,384,2142208,256,354816,5632
.long 262144,262272,262400,262528,262656,262784,262912,263040
.long 0,196608,393216,589824,786432,983040,1179648,1376256
.long 1664,353920,1536,2080768,18432,117760,368,4400
.long 8960,721152,3751936,640,2146304,256,354880,5632
.long 262144,262272,262400,262528,262656,262784,262912,263040
.long 0,196608,393216,589824,786432,983040,1179648,1376256
.long 1920,354176,1792,2088960,18432,126464,376,4408
.long 9088,983296,4734976,896,2150400,256,354944,5632
.long 1310720,1310848,1310976,1311104,1311232,1311360,1311488,1311616
.long 0,196608,393216,589824,786432,983040,1179648,1376256
.long 1152,353408,1024,5996544,26624,100352,1376,5408
.long 8704,1245440,5718016,1152,6070272,256,354752,5632
.long 1310720,1310848,1310976,1311104,1311232,1311360,1311488,1311616
.long 0,196608,393216,589824,786432,983040,1179648,1376256
.long 1408,353664,1280,6004736,26624,109056,1384,5416
.long 8832,1507584,6701056,1408,6074368,256,354816,5632
.long 1310720,1310848,1310976,1311104,1311232,1311360,1311488,1311616
.long 0,196608,393216,589824,786432,983040,1179648,1376256
.long 1664,353920,1536,6012928,26624,117760,1392,5424
.long 8960,1769728,7684096,1664,6078464,256,354880,5632
.long 1310720,1310848,1310976,1311104,1311232,1311360,1311488,1311616
.long 0,196608,393216,589824,786432,983040,1179648,1376256
.long 1920,354176,1792,6021120,26624,126464,1400,5432
.long 9088,2031872,8667136,1920,6082560,256,354944,5632
.long 393344,393472,393600,393728,393856,393984,394112,393216
.long 196608,393216,589824,786432,983040,1179648,1376256,0
.long 1152,529536,1024,2555904,19456,100352,480,4512
.long 8704,196992,1785856,128,2629632,384,530880,7680
.long 393344,393472,393600,393728,393856,393984,394112,393216
.long 196608,393216,589824,786432,983040,1179648,1376256,0
.long 1408,529792,1280,2564096,19456,109056,488,4520
.long 8832,459136,2768896,384,2633728,384,530944,7680
.long 393344,393472,393600,393728,393856,393984,394112,393216
.long 196608,393216,589824,786432,983040,1179648,1376256,0
.long 1664,530048,1536,2572288,19456,117760,496,4528
.long 8960,721280,3751936,640,2637824,384,531008,7680
.long 393344,393472,393600,393728,393856,393984,394112,393216
.long 196608,393216,589824,786432,983040,1179648,1376256,0
.long 1920,530304,1792,2580480,19456,126464,504,4536
.long 9088,983424,4734976,896,2641920,384,531072,7680
.long 1441920,1442048,1442176,1442304,1442432,1442560,1442688,1441792
.long 196608,393216,589824,786432,983040,1179648,1376256,0
.long 1152,529536,1024,6488064,27648,100352,1504,5536
.long 8704,1245568,5718016,1152,6561792,384,530880,7680
.long 1441920,1442048,1442176,1442304,1442432,1442560,1442688,1441792
.long 196608,393216,589824,786432,983040,1179648,1376256,0
.long 1408,529792,1280,6496256,27648,109056,1512,5544
.long 8832,1507712,6701056,1408,6565888,384,530944,7680
.long 1441920,1442048,1442176,1442304,1442432,1442560,1442688,1441792
.long 196608,393216,589824,786432,983040,1179648,1376256,0
.long 1664,530048,1536,6504448,27648,117760,1520,5552
.long 8960,1769856,7684096,1664,6569984,384,531008,7680
.long 1441920,1442048,1442176,1442304,1442432,1442560,1442688,1441792
.long 196608,393216,589824,786432,983040,1179648,1376256,0
.long 1920,530304,1792,6512640,27648,126464,1528,5560
.long 9088,2032000,8667136,1920,6574080,384,531072,7680
.long 524544,524672,524800,524928,525056,525184,524288,524416
.long 393216,589824,786432,983040,1179648,1376256,0,196608
.long 1152,705664,1024,3047424,20480,100352,608,4640
.long 8704,197120,1785856,128,3121152,512,707008,9728
.long 524544,524672,524800,524928,525056,525184,524288,524416
.long 393216,589824,786432,983040,1179648,1376256,0,196608
.long 1408,705920,1280,3055616,20480,109056,616,4648
.long 8832,459264,2768896,384,3125248,512,707072,9728
.long 524544,524672,524800,524928,525056,525184,524288,524416
.long 393216,589824,786432,983040,1179648,1376256,0,196608
.long 1664,706176,1536,3063808,20480,117760,624,4656
.long 8960,721408,3751936,640,3129344,512,707136,9728
.long 524544,524672,524800,524928,525056,525184,524288,524416
.long 393216,589824,786432,983040,1179648,1376256,0,196608
.long 1920,706432,1792,3072000,20480,126464,632,4664
.long 9088,983552,4734976,896,3133440,512,707200,9728
.long 1573120,1573248,1573376,1573504,1573632,1573760,1572864,1572992
.long 393216,589824,786432,983040,1179648,1376256,0,196608
.long 1152,705664,1024,6979584,28672,100352,1632,5664
.long 8704,1245696,5718016,1152,7053312,512,707008,9728
.long 1573120,1573248,1573376,1573504,1573632,1573760,1572864,1572992
.long 393216,589824,786432,983040,1179648,1376256,0,196608
.long 1408,705920,1280,6987776,28672,109056,1640,5672
.long 8832,1507840,6701056,1408,7057408,512,707072,9728
.long 1573120,1573248,1573376,1573504,1573632,1573760,1572864,1572992
.long 393216,589824,786432,983040,1179648,1376256,0,196608
.long 1664,706176,1536,6995968,28672,117760,1648,5680
.long 8960,1769984,7684096,1664,7061504,512,707136,9728
.long 1573120,1573248,1573376,1573504,1573632,1573760,1572864,1572992
.long 393216,589824,786432,983040,1179648,1376256,0,196608
.long 1920,706432,1792,7004160,28672,126464,1656,5688
.long 9088,2032128,8667136,1920,7065600,512,707200,9728
.long 655744,655872,656000,656128,656256,655360,655488,655616
.long 589824,786432,983040,1179648,1376256,0,196608,393216
.long 1152,881792,1024,3538944,21504,100352,736,4768
.long 8704,197248,1785856,128,3612672,640,883136,11776
.long 655744,655872,656000,656128,656256,655360,655488,655616
.long 589824,786432,983040,1179648,1376256,0,196608,393216
.long 1408,882048,1280,3547136,21504,109056,744,4776
.long 8832,459392,2768896,384,3616768,640,883200,11776
.long 655744,655872,656000,656128,656256,655360,655488,655616
.long 589824,786432,983040,1179648,1376256,0,196608,393216
.long 1664,882304,1536,3555328,21504,117760,752,4784
.long 8960,721536,3751936,640,3620864,640,883264,11776
.long 655744,655872,656000,656128,656256,655360,655488,655616
.long 589824,786432,983040,1179648,1376256,0,196608,393216
.long 1920,882560,1792,3563520,21504,126464,760,4792
.long 9088,983680,4734976,896,3624960,640,883328,11776
.long 1704320,1704448,1704576,1704704,1704832,1703936,1704064,1704192
.long 589824,786432,983040,1179648,1376256,0,196608,393216
.long 1152,881792,1024,7471104,29696,100352,1760,5792
.long 8704,1245824,5718016,1152,7544832,640,883136,11776
.long 1704320,1704448,1704576,1704704,1704832,1703936,1704064,1704192
.long 589824,786432,983040,1179648,1376256,0,196608,393216
.long 1408,882048,1280,7479296,29696,109056,1768,5800
.long 8832,1507968,6701056,1408,7548928,640,883200,11776
.long 1704320,1704448,1704576,1704704,1704832,1703936,1704064,1704192
.long 589824,786432,983040,1179648,1376256,0,196608,393216
.long 1664,882304,1536,7487488,29696,117760,1776,5808
.long 8960,1770112,7684096,1664,7553024,640,883264,11776
.long 1704320,1704448,1704576,1704704,1704832,1703936,1704064,1704192
.long 589824,786432,983040,1179648,1376256,0,196608,393216
.long 1920,882560,1792,7495680,29696,126464,1784,5816
.long 9088,2032256,8667136,1920,7557120,640,883328,11776
.long 786944,787072,787200,787328,786432,786560,786688,786816
.long 786432,983040,1179648,1376256,0,196608,393216,589824
.long 1152,1057920,1024,4030464,22528,100352,864,4896
.long 8704,197376,1785856,128,4104192,768,1059264,13824
.long 786944,787072,787200,787328,786432,786560,786688,786816
.long 786432,983040,1179648,1376256,0,196608,393216,589824
.long 1408,1058176,1280,4038656,22528,109056,872,4904
.long 8832,459520,2768896,384,4108288,768,1059328,13824
.long 786944,787072,787200,787328,786432,786560,786688,786816
.long 786432,983040,1179648,1376256,0,196608,393216,589824
.long 1664,1058432,1536,4046848,22528,117760,880,4912
.long 8960,721664,3751936,640,4112384,768,1059392,13824
.long 786944,787072,787200,787328,786432,786560,786688,786816
.long 786432,983040,1179648,1376256,0,196608,393216,589824
.long 1920,1058688,1792,4055040,22528,126464,888,4920
.long 9088,983808,4734976,896,4116480,768,1059456,13824
.long 1835520,1835648,1835776,1835904,1835008,1835136,1835264,1835392
.long 786432,983040,1179648,1376256,0,196608,393216,589824
.long 1152,1057920,1024,7962624,30720,100352,1888,5920
.long 8704,1245952,5718016,1152,8036352,768,1059264,13824
.long 1835520,1835648,1835776,1835904,1835008,1835136,1835264,1835392
.long 786432,983040,1179648,1376256,0,196608,393216,589824
.long 1408,1058176,1280,7970816,30720,109056,1896,5928
.long 8832,1508096,6701056,1408,8040448,768,1059328,13824
.long 1835520,1835648,1835776,1835904,1835008,1835136,1835264,1835392
.long 786432,983040,1179648,1376256,0,196608,393216,589824
.long 1664,1058432,1536,7979008,30720,117760,1904,5936
.long 8960,1770240,7684096,1664,8044544,768,1059392,13824
.long 1835520,1835648,1835776,1835904,1835008,1835136,1835264,1835392
.long 786432,983040,1179648,1376256,0,196608,393216,589824
.long 1920,1058688,1792,7987200,30720,126464,1912,5944
.long 9088,2032384,8667136,1920,8048640,768,1059456,13824
.long 918144,918272,918400,917504,917632,917760,917888,918016
.long 983040,1179648,1376256,0,196608,393216,589824,786432
.long 1152,1234048,1024,4521984,23552,100352,992,5024
.long 8704,197504,1785856,128,4595712,896,1235392,15872
.long 918144,918272,918400,917504,917632,917760,917888,918016
.long 983040,1179648,1376256,0,196608,393216,589824,786432
.long 1408,1234304,1280,4530176,23552,109056,1000,5032
.long 8832,459648,2768896,384,4599808,896,1235456,15872
.long 918144,918272,918400,917504,917632,917760,917888,918016
.long 983040,1179648,1376256,0,196608,393216,589824,786432
.long 1664,1234560,1536,4538368,23552,117760,1008,5040
.long 8960,721792,3751936,640,4603904,896,1235520,15872
.long 918144,918272,918400,917504,917632,917760,917888,918016
.long 983040,1179648,1376256,0,196608,393216,589824,786432
.long 1920,1234816,1792,4546560,23552,126464,1016,5048
.long 9088,983936,4734976,896,4608000,896,1235584,15872
.long 1966720,1966848,1966976,1966080,1966208,1966336,1966464,1966592
.long 983040,1179648,1376256,0,196608,393216,589824,786432
.long 1152,1234048,1024,8454144,31744,100352,2016,6048
.long 8704,1246080,5718016,1152,8527872,896,1235392,15872
.long 1966720,1966848,1966976,1966080,1966208,1966336,1966464,1966592
.long 983040,1179648,1376256,0,196608,393216,589824,786432
.long 1408,1234304,1280,8462336,31744,109056,2024,6056
.long 8832,1508224,6701056,1408,8531968,896,1235456,15872
.long 1966720,1966848,1966976,1966080,1966208,1966336,1966464,1966592
.long 983040,1179648,1376256,0,196608,393216,589824,786432
.long 1664,1234560,1536,8470528,31744,117760,2032,6064
.long 8960,1770368,7684096,1664,8536064,896,1235520,15872
.long 1966720,1966848,1966976,1966080,1966208,1966336,1966464,1966592
.long 983040,1179648,1376256,0,196608,393216,589824,786432
.long 1920,1234816,1792,8478720,31744,126464,2040,6072
.long 9088,2032512,8667136,1920,8540160,896,1235584,15872
.long 0,0,0,0,0,0,0,0
.long 0,2,4,6,0,2048,4096,6144
.long 122880,256,0,122880,4096,0,0,0
.long 2,4,6,0,2048,4096,6144,0
.long 245760,512,0,0,8192,0,0,128
.long 4,6,0,2,4096,6144,0,2048
.long 368640,768,0,122880,12288,0,0,128
.long 6,0,2,4,6144,0,2048,4096
.long 2048,0,4352,0,0,1024,64,256
.long 4,6,0,2,4096,6144,0,2048
.long 124928,256,4352,122880,4096,1024,64,256
.long 6,0,2,4,6144,0,2048,4096
.long 247808,512,4352,0,8192,1024,64,384
.long 0,2,4,6,0,2048,4096,6144
.long 370688,768,4352,122880,12288,1024,64,384
.long 2,4,6,0,2048,4096,6144,0
.long 0,1024,2048,3072,4096,5120,6144,7168
.long 8192,9216,10240,11264,12288,13312,14336,15360
.long 16384,17408,18432,19456,20480,21504,90112,91136
.long 92160,93184,94208,95232,96256,97280,0,0
.long 22528,23552,24576,25600,26624,27648,28672,29696
.long 30720,31744,32768,33792,34816,35840,36864,37888
.long 38912,39936,40960,41984,43008,44032,98304,99328
.long 100352,101376,102400,103424,104448,105472,0,0
.long 45056,46080,47104,48128,49152,50176,51200,52224
.long 53248,54272,55296,56320,57344,58368,59392,60416
.long 61440,62464,63488,64512,65536,66560,106496,107520
.long 108544,109568,110592,111616,112640,113664,0,0
.long 67584,68608,69632,70656,71680,72704,73728,74752
.long 75776,76800,77824,78848,79872,80896,81920,82944
.long 83968,84992,86016,87040,536958976,536958976,114688,115712
.long 116736,117760,118784,119808,120832,121856,0,0
.long 6144,7168,8192,9216,10240,11264,12288,13312
.long 14336,15360,16384,17408,18432,19456,20480,21504
.long 0,1024,2048,3072,4096,5120,92160,93184
.long 94208,95232,96256,97280,90112,91136,0,0
.long 28672,29696,30720,31744,32768,33792,34816,35840
.long 36864,37888,38912,39936,40960,41984,43008,44032
.long 22528,23552,24576,25600,26624,27648,100352,101376
.long 102400,103424,104448,105472,98304,99328,0,0
.long 51200,52224,53248,54272,55296,56320,57344,58368
.long 59392,60416,61440,62464,63488,64512,65536,66560
.long 45056,46080,47104,48128,49152,50176,108544,109568
.long 110592,111616,112640,113664,106496,107520,0,0
.long 73728,74752,75776,76800,77824,78848,79872,80896
.long 81920,82944,83968,84992,86016,87040,536958976,536958976
.long 67584,68608,69632,70656,71680,72704,116736,117760
.long 118784,119808,120832,121856,114688,115712,0,0
.long 12288,13312,14336,15360,16384,17408,18432,19456
.long 20480,21504,0,1024,2048,3072,4096,5120
.long 6144,7168,8192,9216,10240,11264,94208,95232
.long 96256,97280,90112,91136,92160,93184,0,0
.long 34816,35840,36864,37888,38912,39936,40960,41984
.long 43008,44032,22528,23552,24576,25600,26624,27648
.long 28672,29696,30720,31744,32768,33792,102400,103424
.long 104448,105472,98304,99328,100352,101376,0,0
.long 57344,58368,59392,60416,61440,62464,63488,64512
.long 65536,66560,45056,46080,47104,48128,49152,50176
.long 51200,52224,53248,54272,55296,56320,110592,111616
.long 112640,113664,106496,107520,108544,109568,0,0
.long 79872,80896,81920,82944,83968,84992,86016,87040
.long 536958976,536958976,67584,68608,69632,70656,71680,72704
.long 73728,74752,75776,76800,77824,78848,118784,119808
.long 120832,121856,114688,115712,116736,117760,0,0
.long 18432,19456,20480,21504,0,1024,2048,3072
.long 4096,5120,6144,7168,8192,9216,10240,11264
.long 12288,13312,14336,15360,16384,17408,96256,97280
.long 90112,91136,92160,93184,94208,95232,0,0
.long 40960,41984,43008,44032,22528,23552,24576,25600
.long 26624,27648,28672,29696,30720,31744,32768,33792
.long 34816,35840,36864,37888,38912,39936,104448,105472
.long 98304,99328,100352,101376,102400,103424,0,0
.long 63488,64512,65536,66560,45056,46080,47104,48128
.long 49152,50176,51200,52224,53248,54272,55296,56320
.long 57344,58368,59392,60416,61440,62464,112640,113664
.long 106496,107520,108544,109568,110592,111616,0,0
.long 86016,87040,536958976,536958976,67584,68608,69632,70656
.long 71680,72704,73728,74752,75776,76800,77824,78848
.long 79872,80896,81920,82944,83968,84992,120832,121856
.long 114688,115712,116736,117760,118784,119808,0,0
.long 3072,4096,5120,6144,7168,8192,9216,10240
.long 11264,12288,13312,14336,15360,16384,17408,18432
.long 19456,20480,21504,0,1024,2048,91136,92160
.long 93184,94208,95232,96256,97280,90112,0,0
.long 25600,26624,27648,28672,29696,30720,31744,32768
.long 33792,34816,35840,36864,37888,38912,39936,40960
.long 41984,43008,44032,22528,23552,24576,99328,100352
.long 101376,102400,103424,104448,105472,98304,0,0
.long 48128,49152,50176,51200,52224,53248,54272,55296
.long 56320,57344,58368,59392,60416,61440,62464,63488
.long 64512,65536,66560,45056,46080,47104,107520,108544
.long 109568,110592,111616,112640,113664,106496,0,0
.long 70656,71680,72704,73728,74752,75776,76800,77824
.long 78848,79872,80896,81920,82944,83968,84992,86016
.long 87040,536958976,536958976,67584,68608,69632,115712,116736
.long 117760,118784,119808,120832,121856,114688,0,0
.long 9216,10240,11264,12288,13312,14336,15360,16384
.long 17408,18432,19456,20480,21504,0,1024,2048
.long 3072,4096,5120,6144,7168,8192,93184,94208
.long 95232,96256,97280,90112,91136,92160,0,0
.long 31744,32768,33792,34816,35840,36864,37888,38912
.long 39936,40960,41984,43008,44032,22528,23552,24576
.long 25600,26624,27648,28672,29696,30720,101376,102400
.long 103424,104448,105472,98304,99328,100352,0,0
.long 54272,55296,56320,57344,58368,59392,60416,61440
.long 62464,63488,64512,65536,66560,45056,46080,47104
.long 48128,49152,50176,51200,52224,53248,109568,110592
.long 111616,112640,113664,106496,107520,108544,0,0
.long 76800,77824,78848,79872,80896,81920,82944,83968
.long 84992,86016,87040,536958976,536958976,67584,68608,69632
.long 70656,71680,72704,73728,74752,75776,117760,118784
.long 119808,120832,121856,114688,115712,116736,0,0
.long 15360,16384,17408,18432,19456,20480,21504,0
.long 1024,2048,3072,4096,5120,6144,7168,8192
.long 9216,10240,11264,12288,13312,14336,95232,96256
.long 97280,90112,91136,92160,93184,94208,0,0
.long 37888,38912,39936,40960,41984,43008,44032,22528
.long 23552,24576,25600,26624,27648,28672,29696,30720
.long 31744,32768,33792,34816,35840,36864,103424,104448
.long 105472,98304,99328,100352,101376,102400,0,0
.long 60416,61440,62464,63488,64512,65536,66560,45056
.long 46080,47104,48128,49152,50176,51200,52224,53248
.long 54272,55296,56320,57344,58368,59392,111616,112640
.long 113664,106496,107520,108544,109568,110592,0,0
.long 82944,83968,84992,86016,87040,536958976,536958976,67584
.long 68608,69632,70656,71680,72704,73728,74752,75776
.long 76800,77824,78848,79872,80896,81920,119808,120832
.long 121856,114688,115712,116736,117760,118784,0,0
.long 21504,0,1024,2048,3072,4096,5120,6144
.long 7168,8192,9216,10240,11264,12288,13312,14336
.long 15360,16384,17408,18432,19456,20480,97280,90112
.long 91136,92160,93184,94208,95232,96256,0,0
.long 44032,22528,23552,24576,25600,26624,27648,28672
.long 29696,30720,31744,32768,33792,34816,35840,36864
.long 37888,38912,39936,40960,41984,43008,105472,98304
.long 99328,100352,101376,102400,103424,104448,0,0
.long 66560,45056,46080,47104,48128,49152,50176,51200
.long 52224,53248,54272,55296,56320,57344,58368,59392
.long 60416,61440,62464,63488,64512,65536,113664,106496
.long 107520,108544,109568,110592,111616,112640,0,0
.long 536958976,67584,68608,69632,70656,71680,72704,73728
.long 74752,75776,76800,77824,78848,79872,80896,81920
.long 82944,83968,84992,86016,87040,536958976,121856,114688
.long 115712,116736,117760,118784,119808,120832,0,0
.long 6144,7168,8192,9216,10240,11264,12288,13312
.long 14336,15360,16384,17408,18432,19456,20480,21504
.long 0,1024,2048,3072,4096,5120,92160,93184
.long 94208,95232,96256,97280,90112,91136,0,0
.long 28672,29696,30720,31744,32768,33792,34816,35840
.long 36864,37888,38912,39936,40960,41984,43008,44032
.long 22528,23552,24576,25600,26624,27648,100352,101376
.long 102400,103424,104448,105472,98304,99328,0,0
.long 51200,52224,53248,54272,55296,56320,57344,58368
.long 59392,60416,61440,62464,63488,64512,65536,66560
.long 45056,46080,47104,48128,49152,50176,108544,109568
.long 110592,111616,112640,113664,106496,107520,0,0
.long 73728,74752,75776,76800,77824,78848,79872,80896
.long 81920,82944,83968,84992,86016,87040,536958976,536958976
.long 67584,68608,69632,70656,71680,72704,116736,117760
.long 118784,119808,120832,121856,114688,115712,0,0
.long 12288,13312,14336,15360,16384,17408,18432,19456
.long 20480,21504,0,1024,2048,3072,4096,5120
.long 6144,7168,8192,9216,10240,11264,94208,95232
.long 96256,97280,90112,91136,92160,93184,0,0
.long 34816,35840,36864,37888,38912,39936,40960,41984
.long 43008,44032,22528,23552,24576,25600,26624,27648
.long 28672,29696,30720,31744,32768,33792,102400,103424
.long 104448,105472,98304,99328,100352,101376,0,0
.long 57344,58368,59392,60416,61440,62464,63488,64512
.long 65536,66560,45056,46080,47104,48128,49152,50176
.long 51200,52224,53248,54272,55296,56320,110592,111616
.long 112640,113664,106496,107520,108544,109568,0,0
.long 79872,80896,81920,82944,83968,84992,86016,87040
.long 536958976,536958976,67584,68608,69632,70656,71680,72704
.long 73728,74752,75776,76800,77824,78848,118784,119808
.long 120832,121856,114688,115712,116736,117760,0,0
.long 18432,19456,20480,21504,0,1024,2048,3072
.long 4096,5120,6144,7168,8192,9216,10240,11264
.long 12288,13312,14336,15360,16384,17408,96256,97280
.long 90112,91136,92160,93184,94208,95232,0,0
.long 40960,41984,43008,44032,22528,23552,24576,25600
.long 26624,27648,28672,29696,30720,31744,32768,33792
.long 34816,35840,36864,37888,38912,39936,104448,105472
.long 98304,99328,100352,101376,102400,103424,0,0
.long 63488,64512,65536,66560,45056,46080,47104,48128
.long 49152,50176,51200,52224,53248,54272,55296,56320
.long 57344,58368,59392,60416,61440,62464,112640,113664
.long 106496,107520,108544,109568,110592,111616,0,0
.long 86016,87040,536958976,536958976,67584,68608,69632,70656
.long 71680,72704,73728,74752,75776,76800,77824,78848
.long 79872,80896,81920,82944,83968,84992,120832,121856
.long 114688,115712,116736,117760,118784,119808,0,0
.long 2048,3072,4096,5120,6144,7168,8192,9216
.long 10240,11264,12288,13312,14336,15360,16384,17408
.long 18432,19456,20480,21504,0,1024,90112,91136
.long 92160,93184,94208,95232,96256,97280,0,0
.long 24576,25600,26624,27648,28672,29696,30720,31744
.long 32768,33792,34816,35840,36864,37888,38912,39936
.long 40960,41984,43008,44032,22528,23552,98304,99328
.long 100352,101376,102400,103424,104448,105472,0,0
.long 47104,48128,49152,50176,51200,52224,53248,54272
.long 55296,56320,57344,58368,59392,60416,61440,62464
.long 63488,64512,65536,66560,45056,46080,106496,107520
.long 108544,109568,110592,111616,112640,113664,0,0
.long 69632,70656,71680,72704,73728,74752,75776,76800
.long 77824,78848,79872,80896,81920,82944,83968,84992
.long 86016,87040,536958976,536958976,67584,68608,114688,115712
.long 116736,117760,118784,119808,120832,121856,0,0
.long 9216,10240,11264,12288,13312,14336,15360,16384
.long 17408,18432,19456,20480,21504,0,1024,2048
.long 3072,4096,5120,6144,7168,8192,93184,94208
.long 95232,96256,97280,90112,91136,92160,0,0
.long 31744,32768,33792,34816,35840,36864,37888,38912
.long 39936,40960,41984,43008,44032,22528,23552,24576
.long 25600,26624,27648,28672,29696,30720,101376,102400
.long 103424,104448,105472,98304,99328,100352,0,0
.long 54272,55296,56320,57344,58368,59392,60416,61440
.long 62464,63488,64512,65536,66560,45056,46080,47104
.long 48128,49152,50176,51200,52224,53248,109568,110592
.long 111616,112640,113664,106496,107520,108544,0,0
.long 76800,77824,78848,79872,80896,81920,82944,83968
.long 84992,86016,87040,536958976,536958976,67584,68608,69632
.long 70656,71680,72704,73728,74752,75776,117760,118784
.long 119808,120832,121856,114688,115712,116736,0,0
.long 15360,16384,17408,18432,19456,20480,21504,0
.long 1024,2048,3072,4096,5120,6144,7168,8192
.long 9216,10240,11264,12288,13312,14336,95232,96256
.long 97280,90112,91136,92160,93184,94208,0,0
.long 37888,38912,39936,40960,41984,43008,44032,22528
.long 23552,24576,25600,26624,27648,28672,29696,30720
.long 31744,32768,33792,34816,35840,36864,103424,104448
.long 105472,98304,99328,100352,101376,102400,0,0
.long 60416,61440,62464,63488,64512,65536,66560,45056
.long 46080,47104,48128,49152,50176,51200,52224,53248
.long 54272,55296,56320,57344,58368,59392,111616,112640
.long 113664,106496,107520,108544,109568,110592,0,0
.long 82944,83968,84992,86016,87040,536958976,536958976,67584
.long 68608,69632,70656,71680,72704,73728,74752,75776
.long 76800,77824,78848,79872,80896,81920,119808,120832
.long 121856,114688,115712,116736,117760,118784,0,0
.long 21504,0,1024,2048,3072,4096,5120,6144
.long 7168,8192,9216,10240,11264,12288,13312,14336
.long 15360,16384,17408,18432,19456,20480,97280,90112
.long 91136,92160,93184,94208,95232,96256,0,0
.long 44032,22528,23552,24576,25600,26624,27648,28672
.long 29696,30720,31744,32768,33792,34816,35840,36864
.long 37888,38912,39936,40960,41984,43008,105472,98304
.long 99328,100352,101376,102400,103424,104448,0,0
.long 66560,45056,46080,47104,48128,49152,50176,51200
.long 52224,53248,54272,55296,56320,57344,58368,59392
.long 60416,61440,62464,63488,64512,65536,113664,106496
.long 107520,108544,109568,110592,111616,112640,0,0
.long 536958976,67584,68608,69632,70656,71680,72704,73728
.long 74752,75776,76800,77824,78848,79872,80896,81920
.long 82944,83968,84992,86016,87040,536958976,121856,114688
.long 115712,116736,117760,118784,119808,120832,0,0
.long 5120,6144,7168,8192,9216,10240,11264,12288
.long 13312,14336,15360,16384,17408,18432,19456,20480
.long 21504,0,1024,2048,3072,4096,91136,92160
.long 93184,94208,95232,96256,97280,90112,0,0
.long 27648,28672,29696,30720,31744,32768,33792,34816
.long 35840,36864,37888,38912,39936,40960,41984,43008
.long 44032,22528,23552,24576,25600,26624,99328,100352
.long 101376,102400,103424,104448,105472,98304,0,0
.long 50176,51200,52224,53248,54272,55296,56320,57344
.long 58368,59392,60416,61440,62464,63488,64512,65536
.long 66560,45056,46080,47104,48128,49152,107520,108544
.long 109568,110592,111616,112640,113664,106496,0,0
.long 72704,73728,74752,75776,76800,77824,78848,79872
.long 80896,81920,82944,83968,84992,86016,87040,536958976
.long 536958976,67584,68608,69632,70656,71680,115712,116736
.long 117760,118784,119808,120832,121856,114688,0,0
.long 12288,13312,14336,15360,16384,17408,18432,19456
.long 20480,21504,0,1024,2048,3072,4096,5120
.long 6144,7168,8192,9216,10240,11264,94208,95232
.long 96256,97280,90112,91136,92160,93184,0,0
.long 34816,35840,36864,37888,38912,39936,40960,41984
.long 43008,44032,22528,23552,24576,25600,26624,27648
.long 28672,29696,30720,31744,32768,33792,102400,103424
.long 104448,105472,98304,99328,100352,101376,0,0
.long 57344,58368,59392,60416,61440,62464,63488,64512
.long 65536,66560,45056,46080,47104,48128,49152,50176
.long 51200,52224,53248,54272,55296,56320,110592,111616
.long 112640,113664,106496,107520,108544,109568,0,0
.long 79872,80896,81920,82944,83968,84992,86016,87040
.long 536958976,536958976,67584,68608,69632,70656,71680,72704
.long 73728,74752,75776,76800,77824,78848,118784,119808
.long 120832,121856,114688,115712,116736,117760,0,0
.long 18432,19456,20480,21504,0,1024,2048,3072
.long 4096,5120,6144,7168,8192,9216,10240,11264
.long 12288,13312,14336,15360,16384,17408,96256,97280
.long 90112,91136,92160,93184,94208,95232,0,0
.long 40960,41984,43008,44032,22528,23552,24576,25600
.long 26624,27648,28672,29696,30720,31744,32768,33792
.long 34816,35840,36864,37888,38912,39936,104448,105472
.long 98304,99328,100352,101376,102400,103424,0,0
.long 63488,64512,65536,66560,45056,46080,47104,48128
.long 49152,50176,51200,52224,53248,54272,55296,56320
.long 57344,58368,59392,60416,61440,62464,112640,113664
.long 106496,107520,108544,109568,110592,111616,0,0
.long 86016,87040,536958976,536958976,67584,68608,69632,70656
.long 71680,72704,73728,74752,75776,76800,77824,78848
.long 79872,80896,81920,82944,83968,84992,120832,121856
.long 114688,115712,116736,117760,118784,119808,0,0
.long 2048,3072,4096,5120,6144,7168,8192,9216
.long 10240,11264,12288,13312,14336,15360,16384,17408
.long 18432,19456,20480,21504,0,1024,90112,91136
.long 92160,93184,94208,95232,96256,97280,0,0
.long 24576,25600,26624,27648,28672,29696,30720,31744
.long 32768,33792,34816,35840,36864,37888,38912,39936
.long 40960,41984,43008,44032,22528,23552,98304,99328
.long 100352,101376,102400,103424,104448,105472,0,0
.long 47104,48128,49152,50176,51200,52224,53248,54272
.long 55296,56320,57344,58368,59392,60416,61440,62464
.long 63488,64512,65536,66560,45056,46080,106496,107520
.long 108544,109568,110592,111616,112640,113664,0,0
.long 69632,70656,71680,72704,73728,74752,75776,76800
.long 77824,78848,79872,80896,81920,82944,83968,84992
.long 86016,87040,536958976,536958976,67584,68608,114688,115712
.long 116736,117760,118784,119808,120832,121856,0,0
.long 8192,9216,10240,11264,12288,13312,14336,15360
.long 16384,17408,18432,19456,20480,21504,0,1024
.long 2048,3072,4096,5120,6144,7168,92160,93184
.long 94208,95232,96256,97280,90112,91136,0,0
.long 30720,31744,32768,33792,34816,35840,36864,37888
.long 38912,39936,40960,41984,43008,44032,22528,23552
.long 24576,25600,26624,27648,28672,29696,100352,101376
.long 102400,103424,104448,105472,98304,99328,0,0
.long 53248,54272,55296,56320,57344,58368,59392,60416
.long 61440,62464,63488,64512,65536,66560,45056,46080
.long 47104,48128,49152,50176,51200,52224,108544,109568
.long 110592,111616,112640,113664,106496,107520,0,0
.long 75776,76800,77824,78848,79872,80896,81920,82944
.long 83968,84992,86016,87040,536958976,536958976,67584,68608
.long 69632,70656,71680,72704,73728,74752,116736,117760
.long 118784,119808,120832,121856,114688,115712,0,0
.long 15360,16384,17408,18432,19456,20480,21504,0
.long 1024,2048,3072,4096,5120,6144,7168,8192
.long 9216,10240,11264,12288,13312,14336,95232,96256
.long 97280,90112,91136,92160,93184,94208,0,0
.long 37888,38912,39936,40960,41984,43008,44032,22528
.long 23552,24576,25600,26624,27648,28672,29696,30720
.long 31744,32768,33792,34816,35840,36864,103424,104448
.long 105472,98304,99328,100352,101376,102400,0,0
.long 60416,61440,62464,63488,64512,65536,66560,45056
.long 46080,47104,48128,49152,50176,51200,52224,53248
.long 54272,55296,56320,57344,58368,59392,111616,112640
.long 113664,106496,107520,108544,109568,110592,0,0
.long 82944,83968,84992,86016,87040,536958976,536958976,67584
.long 68608,69632,70656,71680,72704,73728,74752,75776
.long 76800,77824,78848,79872,80896,81920,119808,120832
.long 121856,114688,115712,116736,117760,118784,0,0
.long 21504,0,1024,2048,3072,4096,5120,6144
.long 7168,8192,9216,10240,11264,12288,13312,14336
.long 15360,16384,17408,18432,19456,20480,97280,90112
.long 91136,92160,93184,94208,95232,96256,0,0
.long 44032,22528,23552,24576,25600,26624,27648,28672
.long 29696,30720,31744,32768,33792,34816,35840,36864
.long 37888,38912,39936,40960,41984,43008,105472,98304
.long 99328,100352,101376,102400,103424,104448,0,0
.long 66560,45056,46080,47104,48128,49152,50176,51200
.long 52224,53248,54272,55296,56320,57344,58368,59392
.long 60416,61440,62464,63488,64512,65536,113664,106496
.long 107520,108544,109568,110592,111616,112640,0,0
.long 536958976,67584,68608,69632,70656,71680,72704,73728
.long 74752,75776,76800,77824,78848,79872,80896,81920
.long 82944,83968,84992,86016,87040,536958976,121856,114688
.long 115712,116736,117760,118784,119808,120832,0,0
.long 5120,6144,7168,8192,9216,10240,11264,12288
.long 13312,14336,15360,16384,17408,18432,19456,20480
.long 21504,0,1024,2048,3072,4096,91136,92160
.long 93184,94208,95232,96256,97280,90112,0,0
.long 27648,28672,29696,30720,31744,32768,33792,34816
.long 35840,36864,37888,38912,39936,40960,41984,43008
.long 44032,22528,23552,24576,25600,26624,99328,100352
.long 101376,102400,103424,104448,105472,98304,0,0
.long 50176,51200,52224,53248,54272,55296,56320,57344
.long 58368,59392,60416,61440,62464,63488,64512,65536
.long 66560,45056,46080,47104,48128,49152,107520,108544
.long 109568,110592,111616,112640,113664,106496,0,0
.long 72704,73728,74752,75776,76800,77824,78848,79872
.long 80896,81920,82944,83968,84992,86016,87040,536958976
.long 536958976,67584,68608,69632,70656,71680,115712,116736
.long 117760,118784,119808,120832,121856,114688,0,0
.long 11264,12288,13312,14336,15360,16384,17408,18432
.long 19456,20480,21504,0,1024,2048,3072,4096
.long 5120,6144,7168,8192,9216,10240,93184,94208
.long 95232,96256,97280,90112,91136,92160,0,0
.long 33792,34816,35840,36864,37888,38912,39936,40960
.long 41984,43008,44032,22528,23552,24576,25600,26624
.long 27648,28672,29696,30720,31744,32768,101376,102400
.long 103424,104448,105472,98304,99328,100352,0,0
.long 56320,57344,58368,59392,60416,61440,62464,63488
.long 64512,65536,66560,45056,46080,47104,48128,49152
.long 50176,51200,52224,53248,54272,55296,109568,110592
.long 111616,112640,113664,106496,107520,108544,0,0
.long 78848,79872,80896,81920,82944,83968,84992,86016
.long 87040,536958976,536958976,67584,68608,69632,70656,71680
.long 72704,73728,74752,75776,76800,77824,117760,118784
.long 119808,120832,121856,114688,115712,116736,0,0
.long 18432,19456,20480,21504,0,1024,2048,3072
.long 4096,5120,6144,7168,8192,9216,10240,11264
.long 12288,13312,14336,15360,16384,17408,96256,97280
.long 90112,91136,92160,93184,94208,95232,0,0
.long 40960,41984,43008,44032,22528,23552,24576,25600
.long 26624,27648,28672,29696,30720,31744,32768,33792
.long 34816,35840,36864,37888,38912,39936,104448,105472
.long 98304,99328,100352,101376,102400,103424,0,0
.long 63488,64512,65536,66560,45056,46080,47104,48128
.long 49152,50176,51200,52224,53248,54272,55296,56320
.long 57344,58368,59392,60416,61440,62464,112640,113664
.long 106496,107520,108544,109568,110592,111616,0,0
.long 86016,87040,536958976,536958976,67584,68608,69632,70656
.long 71680,72704,73728,74752,75776,76800,77824,78848
.long 79872,80896,81920,82944,83968,84992,120832,121856
.long 114688,115712,116736,117760,118784,119808,0,0
.long 2048,3072,4096,5120,6144,7168,8192,9216
.long 10240,11264,12288,13312,14336,15360,16384,17408
.long 18432,19456,20480,21504,0,1024,90112,91136
.long 92160,93184,94208,95232,96256,97280,0,0
.long 24576,25600,26624,27648,28672,29696,30720,31744
.long 32768,33792,34816,35840,36864,37888,38912,39936
.long 40960,41984,43008,44032,22528,23552,98304,99328
.long 100352,101376,102400,103424,104448,105472,0,0
.long 47104,48128,49152,50176,51200,52224,53248,54272
.long 55296,56320,57344,58368,59392,60416,61440,62464
.long 63488,64512,65536,66560,45056,46080,106496,107520
.long 108544,109568,110592,111616,112640,113664,0,0
.long 69632,70656,71680,72704,73728,74752,75776,76800
.long 77824,78848,79872,80896,81920,82944,83968,84992
.long 86016,87040,536958976,536958976,67584,68608,114688,115712
.long 116736,117760,118784,119808,120832,121856,0,0
.long 8192,9216,10240,11264,12288,13312,14336,15360
.long 16384,17408,18432,19456,20480,21504,0,1024
.long 2048,3072,4096,5120,6144,7168,92160,93184
.long 94208,95232,96256,97280,90112,91136,0,0
.long 30720,31744,32768,33792,34816,35840,36864,37888
.long 38912,39936,40960,41984,43008,44032,22528,23552
.long 24576,25600,26624,27648,28672,29696,100352,101376
.long 102400,103424,104448,105472,98304,99328,0,0
.long 53248,54272,55296,56320,57344,58368,59392,60416
.long 61440,62464,63488,64512,65536,66560,45056,46080
.long 47104,48128,49152,50176,51200,52224,108544,109568
.long 110592,111616,112640,113664,106496,107520,0,0
.long 75776,76800,77824,78848,79872,80896,81920,82944
.long 83968,84992,86016,87040,536958976,536958976,67584,68608
.long 69632,70656,71680,72704,73728,74752,116736,117760
.long 118784,119808,120832,121856,114688,115712,0,0
.long 14336,15360,16384,17408,18432,19456,20480,21504
.long 0,1024,2048,3072,4096,5120,6144,7168
.long 8192,9216,10240,11264,12288,13312,94208,95232
.long 96256,97280,90112,91136,92160,93184,0,0
.long 36864,37888,38912,39936,40960,41984,43008,44032
.long 22528,23552,24576,25600,26624,27648,28672,29696
.long 30720,31744,32768,33792,34816,35840,102400,103424
.long 104448,105472,98304,99328,100352,101376,0,0
.long 59392,60416,61440,62464,63488,64512,65536,66560
.long 45056,46080,47104,48128,49152,50176,51200,52224
.long 53248,54272,55296,56320,57344,58368,110592,111616
.long 112640,113664,106496,107520,108544,109568,0,0
.long 81920,82944,83968,84992,86016,87040,536958976,536958976
.long 67584,68608,69632,70656,71680,72704,73728,74752
.long 75776,76800,77824,78848,79872,80896,118784,119808
.long 120832,121856,114688,115712,116736,117760,0,0
.long 21504,0,1024,2048,3072,4096,5120,6144
.long 7168,8192,9216,10240,11264,12288,13312,14336
.long 15360,16384,17408,18432,19456,20480,97280,90112
.long 91136,92160,93184,94208,95232,96256,0,0
.long 44032,22528,23552,24576,25600,26624,27648,28672
.long 29696,30720,31744,32768,33792,34816,35840,36864
.long 37888,38912,39936,40960,41984,43008,105472,98304
.long 99328,100352,101376,102400,103424,104448,0,0
.long 66560,45056,46080,47104,48128,49152,50176,51200
.long 52224,53248,54272,55296,56320,57344,58368,59392
.long 60416,61440,62464,63488,64512,65536,113664,106496
.long 107520,108544,109568,110592,111616,112640,0,0
.long 536958976,67584,68608,69632,70656,71680,72704,73728
.long 74752,75776,76800,77824,78848,79872,80896,81920
.long 82944,83968,84992,86016,87040,536958976,121856,114688
.long 115712,116736,117760,118784,119808,120832,0,0
.long 5120,6144,7168,8192,9216,10240,11264,12288
.long 13312,14336,15360,16384,17408,18432,19456,20480
.long 21504,0,1024,2048,3072,4096,91136,92160
.long 93184,94208,95232,96256,97280,90112,0,0
.long 27648,28672,29696,30720,31744,32768,33792,34816
.long 35840,36864,37888,38912,39936,40960,41984,43008
.long 44032,22528,23552,24576,25600,26624,99328,100352
.long 101376,102400,103424,104448,105472,98304,0,0
.long 50176,51200,52224,53248,54272,55296,56320,57344
.long 58368,59392,60416,61440,62464,63488,64512,65536
.long 66560,45056,46080,47104,48128,49152,107520,108544
.long 109568,110592,111616,112640,113664,106496,0,0
.long 72704,73728,74752,75776,76800,77824,78848,79872
.long 80896,81920,82944,83968,84992,86016,87040,536958976
.long 536958976,67584,68608,69632,70656,71680,115712,116736
.long 117760,118784,119808,120832,121856,114688,0,0
.long 11264,12288,13312,14336,15360,16384,17408,18432
.long 19456,20480,21504,0,1024,2048,3072,4096
.long 5120,6144,7168,8192,9216,10240,93184,94208
.long 95232,96256,97280,90112,91136,92160,0,0
.long 33792,34816,35840,36864,37888,38912,39936,40960
.long 41984,43008,44032,22528,23552,24576,25600,26624
.long 27648,28672,29696,30720,31744,32768,101376,102400
.long 103424,104448,105472,98304,99328,100352,0,0
.long 56320,57344,58368,59392,60416,61440,62464,63488
.long 64512,65536,66560,45056,46080,47104,48128,49152
.long 50176,51200,52224,53248,54272,55296,109568,110592
.long 111616,112640,113664,106496,107520,108544,0,0
.long 78848,79872,80896,81920,82944,83968,84992,86016
.long 87040,536958976,536958976,67584,68608,69632,70656,71680
.long 72704,73728,74752,75776,76800,77824,117760,118784
.long 119808,120832,121856,114688,115712,116736,0,0
.long 17408,18432,19456,20480,21504,0,1024,2048
.long 3072,4096,5120,6144,7168,8192,9216,10240
.long 11264,12288,13312,14336,15360,16384,95232,96256
.long 97280,90112,91136,92160,93184,94208,0,0
.long 39936,40960,41984,43008,44032,22528,23552,24576
.long 25600,26624,27648,28672,29696,30720,31744,32768
.long 33792,34816,35840,36864,37888,38912,103424,104448
.long 105472,98304,99328,100352,101376,102400,0,0
.long 62464,63488,64512,65536,66560,45056,46080,47104
.long 48128,49152,50176,51200,52224,53248,54272,55296
.long 56320,57344,58368,59392,60416,61440,111616,112640
.long 113664,106496,107520,108544,109568,110592,0,0
.long 84992,86016,87040,536958976,536958976,67584,68608,69632
.long 70656,71680,72704,73728,74752,75776,76800,77824
.long 78848,79872,80896,81920,82944,83968,119808,120832
.long 121856,114688,115712,116736,117760,118784,0,0
```
